```python
import torch

def _softmax(x, axis=-1):
    return torch.softmax(x, dim=axis)
def _gelu(x):
    return torch.nn.functional.gelu(x, approximate="tanh")
def _silu(x):
    return torch.nn.functional.silu(x)
def _sigmoid(x):
    return torch.sigmoid(x)
def _layernorm(x, axis=-1, eps=1e-5):
    m = x.mean(dim=axis, keepdim=True)
    v = x.var(dim=axis, keepdim=True, unbiased=False)
    return (x - m) / torch.sqrt(v + eps)
def _scatter_add(tgt, idx, src, axis=0):
    return tgt.clone().index_add_(axis, idx, src)
def _segment_sum(src, seg, n):
    out = torch.zeros((n,) + src.shape[1:], dtype=src.dtype)
    return out.index_add_(0, seg, src)
def _pad(x, pw):
    flat = tuple(v for pair in reversed(pw) for v in pair)
    return torch.nn.functional.pad(x, flat)

kernel_name = 'recurrent_scan__ssm_conv_s5__glu_gated_swiglu__prompt'

def setup_inputs():

    _w = (lambda a: (lambda t: t.to(torch.bfloat16) if t.is_floating_point() else t)(torch.as_tensor(a)))
    def _A_setup():
        B, S, D = 1, 2048, 512
        P = D
        Lambda_re = -0.5 * (lambda _x: torch.exp(torch.as_tensor(_x)))((lambda *s: torch.randn(*s, dtype=torch.bfloat16) * 0.8)(P))
        Lambda_im = (lambda *s: torch.randn(*s, dtype=torch.bfloat16) * 0.8)(P) * 1.0
        B_re = (lambda *s: torch.randn(*s, dtype=torch.bfloat16) * 0.8)(P, D) * (D ** -0.5)
        B_im = (lambda *s: torch.randn(*s, dtype=torch.bfloat16) * 0.8)(P, D) * (D ** -0.5)
        C_re = (lambda *s: torch.randn(*s, dtype=torch.bfloat16) * 0.8)(D, P) * (P ** -0.5)
        C_im = (lambda *s: torch.randn(*s, dtype=torch.bfloat16) * 0.8)(D, P) * (P ** -0.5)
        log_dt = (lambda *s: torch.randn(*s, dtype=torch.bfloat16) * 0.8)(P) * 0.3 - 2.0
        Dskip = (lambda *s: torch.randn(*s, dtype=torch.bfloat16) * 0.8)(D)
        return {
            "x": _w((lambda *s: torch.randn(*s, dtype=torch.bfloat16) * 0.05)(B, S, D)),
            "Lambda_re": _w(Lambda_re),
            "Lambda_im": _w(Lambda_im),
            "B_re": _w(B_re),
            "B_im": _w(B_im),
            "C_re": _w(C_re),
            "C_im": _w(C_im),
            "log_dt": _w(log_dt),
            "Dskip": _w(Dskip),
        }
    _A_in = _A_setup()

    def _B_setup():
        B, S, D, F = 1, 2048, 512, 1792
        return {
            "x": _w((lambda *s: torch.randn(*s, dtype=torch.bfloat16) * 0.05)(B, S, D)),
            "w1": _w((lambda *s: torch.randn(*s, dtype=torch.bfloat16) * 0.2)(D, F) * (2.0 / D) ** 0.5),
            "w3": _w((lambda *s: torch.randn(*s, dtype=torch.bfloat16) * 0.2)(D, F) * (2.0 / D) ** 0.5),
            "w2": _w((lambda *s: torch.randn(*s, dtype=torch.bfloat16) * 0.2)(F, D) * (2.0 / F) ** 0.5),
        }
    _B_in = _B_setup()

    return {
        "A_x": _A_in["x"],
        "A_Lambda_re": _A_in["Lambda_re"],
        "A_Lambda_im": _A_in["Lambda_im"],
        "A_B_re": _A_in["B_re"],
        "A_B_im": _A_in["B_im"],
        "A_C_re": _A_in["C_re"],
        "A_C_im": _A_in["C_im"],
        "A_log_dt": _A_in["log_dt"],
        "A_Dskip": _A_in["Dskip"],
        "B_x": _B_in["x"],
        "B_w1": _B_in["w1"],
        "B_w3": _B_in["w3"],
        "B_w2": _B_in["w2"],
    }

def reference(A_x, A_Lambda_re, A_Lambda_im, A_B_re, A_B_im, A_C_re, A_C_im, A_log_dt, A_Dskip, B_x, B_w1, B_w3, B_w2):
    def _A_ref(x, Lambda_re, Lambda_im, B_re, B_im, C_re, C_im, log_dt, Dskip):
        Bsz, L, H = x.shape
        Lam = Lambda_re + 1j * Lambda_im
        Bmat = B_re + 1j * B_im
        Cmat = C_re + 1j * C_im
        dt = torch.exp(log_dt)
        Lam_bar = torch.exp(dt * Lam)
        B_bar = ((Lam_bar - 1.0) / Lam)[:, None] * Bmat
        Bu = torch.einsum("bld,pd->blp", x + 0j, B_bar)
        h = torch.zeros_like(Bu[:, 0, :])
        hs = []
        for t in range(L):
            h = Lam_bar[None, :] * h + Bu[:, t, :]
            hs.append(h)
        hseq = torch.stack(hs, 1)
        y = 2.0 * torch.einsum("blp,dp->bld", hseq, Cmat).real + x * Dskip[None, None, :]
        return y

    def _B_ref(x, w1, w3, w2):
        gate = torch.einsum("bsd,df->bsf", x, w1)
        up = torch.einsum("bsd,df->bsf", x, w3)
        h = _silu(gate) * up
        out = torch.einsum("bsf,fd->bsd", h, w2)
        return out

    x = A_x
    xn = _layernorm(x, axis=-1)
    s = _A_ref(xn, A_Lambda_re, A_Lambda_im, A_B_re, A_B_im, A_C_re, A_C_im, A_log_dt, A_Dskip)
    g = _silu(_B_ref(xn, B_w1, B_w3, B_w2))
    return x + s * g
```

```asm
; @launch grid=(256,1,1) block=(512,1,1) lds=163840
.amdgcn_target "amdgcn-amd-amdhsa--gfx950"
.text
.globl recurrent_scan__ssm_conv_s5__glu_gated_swiglu__prompt_kernel
.p2align 8
.type recurrent_scan__ssm_conv_s5__glu_gated_swiglu__prompt_kernel,@function
recurrent_scan__ssm_conv_s5__glu_gated_swiglu__prompt_kernel:
  s_cmp_ge_u32 s2, 256
  s_cbranch_scc1 L_exit
  s_load_dwordx16 s[32:47], s[0:1], 0
  s_load_dwordx8 s[52:59], s[0:1], 80
  s_load_dwordx2 s[60:61], s[0:1], 120
  s_load_dwordx2 s[48:49], s[0:1], 64
  v_and_b32 v1, 63, v0
  v_lshrrev_b32 v2, 6, v0
  s_nop 0
  v_readfirstlane_b32 s62, v2
  s_and_b32 s69, s2, 7
  s_lshr_b32 s70, s2, 3
  s_and_b32 s63, s69, 1
  s_lshl_b32 s63, s63, 3
  s_and_b32 s71, s70, 7
  s_add_u32 s63, s63, s71
  s_lshr_b32 s64, s69, 1
  s_lshl_b32 s64, s64, 2
  s_lshr_b32 s72, s70, 3
  s_add_u32 s64, s64, s72
  s_add_u32 s65, s63, s64
  s_and_b32 s65, s65, 7
  s_mov_b32 s84, -1
  s_mov_b32 s85, 0
  s_and_b32 s67, s69, 3
  s_lshl_b32 s67, s67, 3
  s_add_u32 s67, s67, s71
  s_lshr_b32 s68, s69, 2
  s_lshl_b32 s68, s68, 2
  s_add_u32 s68, s68, s72
  s_cmp_lt_u32 s62, 4
  s_cbranch_scc1 L_A
  s_sub_u32 s62, s62, 4
  v_lshrrev_b32 v32, 3, v1
  v_and_b32 v33, 7, v1
  v_lshrrev_b32 v34, 1, v32
  v_xor_b32 v34, v33, v34
  v_lshlrev_b32 v34, 4, v34
  v_xor_b32 v35, 64, v34
  v_lshrrev_b32 v36, 2, v32
  v_lshlrev_b32 v36, 14, v36
  v_and_b32 v37, 3, v32
  v_lshl_add_u32 v36, v37, 10, v36
  v_add_u32 v4, v36, v34
  v_add_u32 v5, v36, v35
  v_add_u32 v6, 6144, v4
  v_add_u32 v7, 6144, v5
  v_add_u32 v5, 3072, v5
  v_add_u32 v7, 3072, v7
  v_lshlrev_b32 v36, 10, v32
  v_add_u32 v8, v36, v34
  v_add_u32 v9, v36, v35
  v_add_u32 v9, 7168, v9
  s_lshl_b32 s73, s63, 17
  s_lshl_b32 s69, s62, 15
  s_add_u32 s73, s73, s69
  s_and_b32 s70, s62, 1
  s_lshl_b32 s74, s64, 15
  s_lshl_b32 s69, s70, 14
  s_add_u32 s74, s74, s69
  s_lshl_b32 s82, s62, 11
  s_lshl_b32 s83, s62, 12
  s_waitcnt lgkmcnt(0)
  s_load_dword s87, s[60:61], 0
  s_mov_b32 s4, s32
  s_mov_b32 s5, s33
  s_mov_b32 s6, 0x200000
  s_mov_b32 s7, 0x00020000
  s_cmp_lt_u32 s62, 2
  s_cselect_b32 s20, s38, s40
  s_cselect_b32 s21, s39, s41
  s_cselect_b32 s24, s52, s54
  s_cselect_b32 s25, s53, s55
  s_mov_b32 s22, 524288
  s_mov_b32 s23, 0x00020000
  s_add_u32 s80, s65, 0
  s_and_b32 s80, s80, 7
  s_lshl_b32 s69, s80, 7
  s_add_u32 s77, s73, s69
  s_add_u32 m0, s83, 0
  s_nop 0
  buffer_load_dwordx4 v4, s[4:7], s77 offen offset:0 lds
  buffer_load_dwordx4 v5, s[4:7], s77 offen offset:1024 lds
  buffer_load_dwordx4 v6, s[4:7], s77 offen offset:2048 lds
  buffer_load_dwordx4 v7, s[4:7], s77 offen offset:3072 lds
  s_add_u32 s80, s65, 0
  s_and_b32 s80, s80, 7
  s_lshl_b32 s69, s80, 7
  s_add_u32 s78, s74, s69
  s_add_u32 m0, s82, 81920
  s_nop 0
  buffer_load_dwordx4 v8, s[20:23], s78 offen offset:0 lds
  buffer_load_dwordx4 v9, s[20:23], s78 offen offset:1024 lds
  s_add_u32 s80, s65, 1
  s_and_b32 s80, s80, 7
  s_lshl_b32 s69, s80, 7
  s_add_u32 s77, s73, s69
  s_add_u32 m0, s83, 16384
  s_nop 0
  buffer_load_dwordx4 v4, s[4:7], s77 offen offset:0 lds
  buffer_load_dwordx4 v5, s[4:7], s77 offen offset:1024 lds
  buffer_load_dwordx4 v6, s[4:7], s77 offen offset:2048 lds
  buffer_load_dwordx4 v7, s[4:7], s77 offen offset:3072 lds
  s_add_u32 s80, s65, 1
  s_and_b32 s80, s80, 7
  s_lshl_b32 s69, s80, 7
  s_add_u32 s78, s74, s69
  s_add_u32 m0, s82, 90112
  s_nop 0
  buffer_load_dwordx4 v8, s[20:23], s78 offen offset:0 lds
  buffer_load_dwordx4 v9, s[20:23], s78 offen offset:1024 lds
  v_lshrrev_b32 v32, 3, v1
  v_and_b32 v33, 7, v1
  v_lshrrev_b32 v34, 1, v33
  v_and_b32 v35, 1, v1
  v_and_b32 v36, 3, v32
  v_xor_b32 v37, v34, v36
  v_lshlrev_b32 v37, 5, v37
  v_lshl_add_u32 v37, v35, 4, v37
  v_mul_u32_u24 v38, 3584, v32
  v_add_u32 v10, v38, v37
  v_add_u32 v11, 27648, v10
  v_xor_b32 v37, 32, v37
  v_xor_b32 v38, 1, v32
  v_mul_u32_u24 v38, 3584, v38
  v_add_u32 v12, v38, v37
  v_add_u32 v13, 27648, v12
  v_add_u32 v32, 0, v1
  v_mul_u32_u24 v33, 0xaaab, v32
  v_lshrrev_b32 v33, 18, v33
  v_mul_u32_u24 v34, 6, v33
  v_sub_u32 v34, v32, v34
  v_mul_u32_u24 v33, 3584, v33
  v_lshl_add_u32 v33, v34, 4, v33
  v_mov_b32 v20, v33
  v_add_u32 v32, 64, v1
  v_mul_u32_u24 v33, 0xaaab, v32
  v_lshrrev_b32 v33, 18, v33
  v_mul_u32_u24 v34, 6, v33
  v_sub_u32 v34, v32, v34
  v_mul_u32_u24 v33, 3584, v33
  v_lshl_add_u32 v33, v34, 4, v33
  v_subrev_u32 v21, 1024, v33
  v_add_u32 v32, 128, v1
  v_mul_u32_u24 v33, 0xaaab, v32
  v_lshrrev_b32 v33, 18, v33
  v_mul_u32_u24 v34, 6, v33
  v_sub_u32 v34, v32, v34
  v_mul_u32_u24 v33, 3584, v33
  v_lshl_add_u32 v33, v34, 4, v33
  v_subrev_u32 v22, 2048, v33
  s_mov_b32 s12, s52
  s_mov_b32 s13, s53
  s_mov_b32 s14, 0x1c0000
  s_mov_b32 s15, 0x00020000
  s_mov_b32 s16, s54
  s_mov_b32 s17, s55
  s_mov_b32 s18, 0x1c0000
  s_mov_b32 s19, 0x00020000
  s_mov_b32 s8, s60
  s_mov_b32 s9, s61
  s_mov_b32 s10, 0x10000000
  s_mov_b32 s11, 0x00020000
  s_mul_i32 s75, s62, 57344
  s_lshl_b32 s69, s64, 7
  s_add_u32 s75, s75, s69
  s_mov_b32 s26, 1835008
  s_mov_b32 s27, 0x00020000
  s_and_b32 s70, s62, 1
  s_mul_i32 s76, s70, 114688
  s_mul_i32 s69, s64, 96
  s_add_u32 s76, s76, s69
  s_add_u32 s76, s76, 2048
  s_lshr_b32 s69, s62, 1
  s_mul_i32 s81, s69, 6272
  s_mul_i32 s69, s70, 3072
  s_add_u32 s81, s81, s69
  v_and_b32 v32, 31, v1
  v_lshrrev_b32 v33, 5, v1
  v_bfe_u32 v34, v1, 1, 3
  v_xor_b32 v34, v34, v33
  v_lshlrev_b32 v34, 4, v34
  v_lshl_add_u32 v34, v32, 7, v34
  v_add_u32 v14, s83, v34
  v_xor_b32 v15, 32, v14
  v_xor_b32 v16, 64, v14
  v_xor_b32 v17, 96, v14
  v_bfe_u32 v35, v1, 4, 1
  v_bfe_u32 v36, v1, 2, 2
  v_and_b32 v37, 3, v1
  v_lshl_add_u32 v38, v33, 3, v36
  v_mul_u32_u24 v39, 96, v38
  v_mul_u32_u24 v40, 6272, v35
  v_add_u32 v39, v39, v40
  v_lshl_add_u32 v27, v37, 3, v39
  v_add_u32 v27, 131072, v27
  v_xor_b32 v38, v38, v35
  v_lshlrev_b32 v38, 7, v38
  v_lshl_add_u32 v38, v35, 13, v38
  v_lshl_add_u32 v38, v36, 5, v38
  v_lshl_add_u32 v38, v37, 3, v38
  v_add_u32 v23, 114688, v38
  v_xor_b32 v24, 32, v23
  v_xor_b32 v25, 64, v23
  v_xor_b32 v26, 96, v23
  v_lshlrev_b32 v28, 4, v1
  v_lshlrev_b32 v39, 2, v1
  v_lshl_add_u32 v2, v37, 8, v39
  v_add_u32 v2, 147456, v2
  s_lshl_b32 s69, s62, 8
  s_add_u32 s69, s69, 148480
  v_add_u32 v31, s69, v39
  v_mov_b32 v18, 0
  ds_write_b32 v31, v18
  v_mov_b32 v112, 0x3f803f80
  v_mov_b32 v113, 0x3f803f80
  s_mov_b32 s92, 0x22222222
  s_mov_b32 s93, 0x22222222
  s_mov_b32 s94, 0x44444444
  s_mov_b32 s95, 0x44444444
  s_mov_b32 s96, 0x88888888
  s_mov_b32 s97, 0x88888888
  s_lshl_b32 s69, s63, 2
  s_add_u32 s69, s69, s62
  s_lshl_b32 s91, s69, 8
  s_lshl_b32 s70, s64, 2
  s_add_u32 s91, s91, s70
  s_add_u32 s91, s91, 32768
  s_mul_i32 s69, s69, 112
  s_add_u32 s88, s69, s70
  s_lshl_b32 s88, s88, 10
  s_add_u32 s88, s88, 1048576
  s_mul_i32 s70, s64, 3
  s_add_u32 s89, s69, s70
  s_add_u32 s89, s89, 64
  s_lshl_b32 s89, s89, 10
  s_add_u32 s89, s89, 1048576
  s_waitcnt vmcnt(8)
  s_waitcnt vmcnt(6)
  s_waitcnt lgkmcnt(0)
  s_mul_i32 s66, s87, 0x9E3779B1
  s_add_u32 s66, s66, 0x7F4A7C15
  s_cmp_eq_u32 s66, 0
  s_cselect_b32 s66, 0x5bd1e995, s66
  s_barrier
  ds_read_b128 v[128:131], v14 offset:0
  ds_read_b128 v[132:135], v15 offset:0
  ds_read_b128 v[136:139], v16 offset:0
  ds_read_b128 v[140:143], v17 offset:0
  s_add_u32 s80, s65, 2
  s_and_b32 s80, s80, 7
  s_lshl_b32 s69, s80, 7
  s_add_u32 s77, s73, s69
  s_add_u32 m0, s83, 32768
  s_nop 0
  buffer_load_dwordx4 v4, s[4:7], s77 offen offset:0 lds
  buffer_load_dwordx4 v5, s[4:7], s77 offen offset:1024 lds
  buffer_load_dwordx4 v6, s[4:7], s77 offen offset:2048 lds
  buffer_load_dwordx4 v7, s[4:7], s77 offen offset:3072 lds
  s_add_u32 s80, s65, 2
  s_and_b32 s80, s80, 7
  s_lshl_b32 s69, s80, 7
  s_add_u32 s78, s74, s69
  s_add_u32 m0, s82, 98304
  s_nop 0
  buffer_load_dwordx4 v8, s[20:23], s78 offen offset:0 lds
  buffer_load_dwordx4 v9, s[20:23], s78 offen offset:1024 lds
  s_add_u32 s80, s65, 3
  s_and_b32 s80, s80, 7
  s_lshl_b32 s69, s80, 7
  s_add_u32 s77, s73, s69
  s_add_u32 m0, s83, 49152
  s_nop 0
  buffer_load_dwordx4 v4, s[4:7], s77 offen offset:0 lds
  buffer_load_dwordx4 v5, s[4:7], s77 offen offset:1024 lds
  buffer_load_dwordx4 v6, s[4:7], s77 offen offset:2048 lds
  buffer_load_dwordx4 v7, s[4:7], s77 offen offset:3072 lds
  s_add_u32 s80, s65, 3
  s_and_b32 s80, s80, 7
  s_lshl_b32 s69, s80, 7
  s_add_u32 s78, s74, s69
  s_add_u32 m0, s82, 106496
  s_nop 0
  buffer_load_dwordx4 v8, s[20:23], s78 offen offset:0 lds
  buffer_load_dwordx4 v9, s[20:23], s78 offen offset:1024 lds
  s_add_u32 s80, s65, 4
  s_and_b32 s80, s80, 7
  s_lshl_b32 s69, s80, 7
  s_add_u32 s77, s73, s69
  s_add_u32 m0, s83, 65536
  s_nop 0
  buffer_load_dwordx4 v4, s[4:7], s77 offen offset:0 lds
  buffer_load_dwordx4 v5, s[4:7], s77 offen offset:1024 lds
  buffer_load_dwordx4 v6, s[4:7], s77 offen offset:2048 lds
  buffer_load_dwordx4 v7, s[4:7], s77 offen offset:3072 lds
  s_waitcnt lgkmcnt(0)
  s_waitcnt vmcnt(18)
  s_waitcnt vmcnt(16)
  s_barrier
  ds_read_b128 v[144:147], v14 offset:16384
  ds_read_b128 v[148:151], v15 offset:16384
  ds_read_b128 v[152:155], v16 offset:16384
  ds_read_b128 v[156:159], v17 offset:16384
  s_add_u32 s80, s65, 4
  s_and_b32 s80, s80, 7
  s_lshl_b32 s69, s80, 7
  s_add_u32 s78, s74, s69
  s_add_u32 m0, s82, 81920
  s_nop 0
  buffer_load_dwordx4 v8, s[20:23], s78 offen offset:0 lds
  buffer_load_dwordx4 v9, s[20:23], s78 offen offset:1024 lds
  s_add_u32 s80, s65, 5
  s_and_b32 s80, s80, 7
  s_lshl_b32 s69, s80, 7
  s_add_u32 s77, s73, s69
  s_add_u32 m0, s83, 0
  s_nop 0
  buffer_load_dwordx4 v4, s[4:7], s77 offen offset:0 lds
  buffer_load_dwordx4 v5, s[4:7], s77 offen offset:1024 lds
  buffer_load_dwordx4 v6, s[4:7], s77 offen offset:2048 lds
  buffer_load_dwordx4 v7, s[4:7], s77 offen offset:3072 lds
  s_add_u32 s80, s65, 0
  s_and_b32 s80, s80, 7
  s_mul_i32 s69, s80, 229376
  s_add_u32 s79, s75, s69
  s_add_u32 m0, s82, 114688
  s_nop 0
  buffer_load_dwordx4 v10, s[12:15], s79 offen offset:0 lds
  buffer_load_dwordx4 v11, s[12:15], s79 offen offset:1024 lds
  s_add_u32 m0, s82, 122880
  s_nop 0
  buffer_load_dwordx4 v12, s[16:19], s79 offen offset:0 lds
  buffer_load_dwordx4 v13, s[16:19], s79 offen offset:1024 lds
  v_mfma_f32_4x4x4_16b_bf16 v[96:99], v[112:113], v[128:129], 0
  v_mfma_f32_4x4x4_16b_bf16 v[104:107], v[128:129], v[128:129], 0
  v_mfma_f32_4x4x4_16b_bf16 v[100:103], v[112:113], v[130:131], 0
  v_mfma_f32_4x4x4_16b_bf16 v[108:111], v[130:131], v[130:131], 0
  v_mfma_f32_4x4x4_16b_bf16 v[96:99], v[112:113], v[132:133], v[96:99]
  v_mfma_f32_4x4x4_16b_bf16 v[104:107], v[132:133], v[132:133], v[104:107]
  v_mfma_f32_4x4x4_16b_bf16 v[100:103], v[112:113], v[134:135], v[100:103]
  v_mfma_f32_4x4x4_16b_bf16 v[108:111], v[134:135], v[134:135], v[108:111]
  v_mfma_f32_4x4x4_16b_bf16 v[96:99], v[112:113], v[136:137], v[96:99]
  v_mfma_f32_4x4x4_16b_bf16 v[104:107], v[136:137], v[136:137], v[104:107]
  v_mfma_f32_4x4x4_16b_bf16 v[100:103], v[112:113], v[138:139], v[100:103]
  v_mfma_f32_4x4x4_16b_bf16 v[108:111], v[138:139], v[138:139], v[108:111]
  v_mfma_f32_4x4x4_16b_bf16 v[96:99], v[112:113], v[140:141], v[96:99]
  v_mfma_f32_4x4x4_16b_bf16 v[104:107], v[140:141], v[140:141], v[104:107]
  v_mfma_f32_4x4x4_16b_bf16 v[100:103], v[112:113], v[142:143], v[100:103]
  v_mfma_f32_4x4x4_16b_bf16 v[108:111], v[142:143], v[142:143], v[108:111]
  s_waitcnt lgkmcnt(0)
  s_waitcnt vmcnt(22)
  s_waitcnt vmcnt(20)
  s_barrier
  ds_read_b128 v[160:163], v14 offset:32768
  ds_read_b128 v[164:167], v15 offset:32768
  ds_read_b128 v[168:171], v16 offset:32768
  ds_read_b128 v[172:175], v17 offset:32768
  s_add_u32 s80, s65, 5
  s_and_b32 s80, s80, 7
  s_lshl_b32 s69, s80, 7
  s_add_u32 s78, s74, s69
  s_add_u32 m0, s82, 90112
  s_nop 0
  buffer_load_dwordx4 v8, s[20:23], s78 offen offset:0 lds
  buffer_load_dwordx4 v9, s[20:23], s78 offen offset:1024 lds
  s_add_u32 s80, s65, 6
  s_and_b32 s80, s80, 7
  s_lshl_b32 s69, s80, 7
  s_add_u32 s77, s73, s69
  s_add_u32 m0, s83, 16384
  s_nop 0
  buffer_load_dwordx4 v4, s[4:7], s77 offen offset:0 lds
  buffer_load_dwordx4 v5, s[4:7], s77 offen offset:1024 lds
  buffer_load_dwordx4 v6, s[4:7], s77 offen offset:2048 lds
  buffer_load_dwordx4 v7, s[4:7], s77 offen offset:3072 lds
  s_add_u32 s80, s65, 0
  s_and_b32 s80, s80, 7
  s_mul_i32 s69, s80, 229376
  s_add_u32 s79, s76, s69
  s_add_u32 m0, s81, 131072
  s_nop 0
  buffer_load_dwordx4 v20, s[24:27], s79 offen lds
  buffer_load_dwordx4 v21, s[24:27], s79 offen offset:1024 lds
  buffer_load_dwordx4 v22, s[24:27], s79 offen offset:2048 lds
  v_mfma_f32_4x4x4_16b_bf16 v[96:99], v[112:113], v[144:145], v[96:99]
  v_mfma_f32_4x4x4_16b_bf16 v[104:107], v[144:145], v[144:145], v[104:107]
  v_mfma_f32_4x4x4_16b_bf16 v[100:103], v[112:113], v[146:147], v[100:103]
  v_mfma_f32_4x4x4_16b_bf16 v[108:111], v[146:147], v[146:147], v[108:111]
  v_mfma_f32_4x4x4_16b_bf16 v[96:99], v[112:113], v[148:149], v[96:99]
  v_mfma_f32_4x4x4_16b_bf16 v[104:107], v[148:149], v[148:149], v[104:107]
  v_mfma_f32_4x4x4_16b_bf16 v[100:103], v[112:113], v[150:151], v[100:103]
  v_mfma_f32_4x4x4_16b_bf16 v[108:111], v[150:151], v[150:151], v[108:111]
  v_mfma_f32_4x4x4_16b_bf16 v[96:99], v[112:113], v[152:153], v[96:99]
  v_mfma_f32_4x4x4_16b_bf16 v[104:107], v[152:153], v[152:153], v[104:107]
  v_mfma_f32_4x4x4_16b_bf16 v[100:103], v[112:113], v[154:155], v[100:103]
  v_mfma_f32_4x4x4_16b_bf16 v[108:111], v[154:155], v[154:155], v[108:111]
  v_mfma_f32_4x4x4_16b_bf16 v[96:99], v[112:113], v[156:157], v[96:99]
  v_mfma_f32_4x4x4_16b_bf16 v[104:107], v[156:157], v[156:157], v[104:107]
  v_mfma_f32_4x4x4_16b_bf16 v[100:103], v[112:113], v[158:159], v[100:103]
  v_mfma_f32_4x4x4_16b_bf16 v[108:111], v[158:159], v[158:159], v[108:111]
  s_waitcnt lgkmcnt(0)
  s_waitcnt vmcnt(25)
  s_waitcnt vmcnt(23)
  s_barrier
  ds_read_b128 v[176:179], v14 offset:49152
  ds_read_b128 v[180:183], v15 offset:49152
  ds_read_b128 v[184:187], v16 offset:49152
  ds_read_b128 v[188:191], v17 offset:49152
  s_add_u32 s80, s65, 6
  s_and_b32 s80, s80, 7
  s_lshl_b32 s69, s80, 7
  s_add_u32 s78, s74, s69
  s_add_u32 m0, s82, 98304
  s_nop 0
  buffer_load_dwordx4 v8, s[20:23], s78 offen offset:0 lds
  buffer_load_dwordx4 v9, s[20:23], s78 offen offset:1024 lds
  s_add_u32 s80, s65, 7
  s_and_b32 s80, s80, 7
  s_lshl_b32 s69, s80, 7
  s_add_u32 s77, s73, s69
  s_add_u32 m0, s83, 32768
  s_nop 0
  buffer_load_dwordx4 v4, s[4:7], s77 offen offset:0 lds
  buffer_load_dwordx4 v5, s[4:7], s77 offen offset:1024 lds
  buffer_load_dwordx4 v6, s[4:7], s77 offen offset:2048 lds
  buffer_load_dwordx4 v7, s[4:7], s77 offen offset:3072 lds
  v_mfma_f32_4x4x4_16b_bf16 v[96:99], v[112:113], v[160:161], v[96:99]
  v_mfma_f32_4x4x4_16b_bf16 v[104:107], v[160:161], v[160:161], v[104:107]
  v_mfma_f32_4x4x4_16b_bf16 v[100:103], v[112:113], v[162:163], v[100:103]
  v_mfma_f32_4x4x4_16b_bf16 v[108:111], v[162:163], v[162:163], v[108:111]
  v_mfma_f32_4x4x4_16b_bf16 v[96:99], v[112:113], v[164:165], v[96:99]
  v_mfma_f32_4x4x4_16b_bf16 v[104:107], v[164:165], v[164:165], v[104:107]
  v_mfma_f32_4x4x4_16b_bf16 v[100:103], v[112:113], v[166:167], v[100:103]
  v_mfma_f32_4x4x4_16b_bf16 v[108:111], v[166:167], v[166:167], v[108:111]
  v_mfma_f32_4x4x4_16b_bf16 v[96:99], v[112:113], v[168:169], v[96:99]
  v_mfma_f32_4x4x4_16b_bf16 v[104:107], v[168:169], v[168:169], v[104:107]
  v_mfma_f32_4x4x4_16b_bf16 v[100:103], v[112:113], v[170:171], v[100:103]
  v_mfma_f32_4x4x4_16b_bf16 v[108:111], v[170:171], v[170:171], v[108:111]
  v_mfma_f32_4x4x4_16b_bf16 v[96:99], v[112:113], v[172:173], v[96:99]
  v_mfma_f32_4x4x4_16b_bf16 v[104:107], v[172:173], v[172:173], v[104:107]
  v_mfma_f32_4x4x4_16b_bf16 v[100:103], v[112:113], v[174:175], v[100:103]
  v_mfma_f32_4x4x4_16b_bf16 v[108:111], v[174:175], v[174:175], v[108:111]
  s_waitcnt lgkmcnt(0)
  s_waitcnt vmcnt(25)
  s_waitcnt vmcnt(23)
  s_waitcnt vmcnt(15)
  s_barrier
  v_add_u32 v14, 65536, v14
  v_add_u32 v15, 65536, v15
  v_add_u32 v16, 65536, v16
  v_add_u32 v17, 65536, v17
  ds_read_b128 v[192:195], v14 offset:0
  ds_read_b128 v[196:199], v15 offset:0
  ds_read_b128 v[200:203], v16 offset:0
  ds_read_b128 v[204:207], v17 offset:0
  s_add_u32 s80, s65, 7
  s_and_b32 s80, s80, 7
  s_lshl_b32 s69, s80, 7
  s_add_u32 s78, s74, s69
  s_add_u32 m0, s82, 106496
  s_nop 0
  buffer_load_dwordx4 v8, s[20:23], s78 offen offset:0 lds
  buffer_load_dwordx4 v9, s[20:23], s78 offen offset:1024 lds
  s_add_u32 s80, s65, 1
  s_and_b32 s80, s80, 7
  s_mul_i32 s69, s80, 229376
  s_add_u32 s79, s75, s69
  s_add_u32 m0, s82, 49152
  s_nop 0
  buffer_load_dwordx4 v10, s[12:15], s79 offen offset:0 lds
  buffer_load_dwordx4 v11, s[12:15], s79 offen offset:1024 lds
  s_add_u32 m0, s82, 57344
  s_nop 0
  buffer_load_dwordx4 v12, s[16:19], s79 offen offset:0 lds
  buffer_load_dwordx4 v13, s[16:19], s79 offen offset:1024 lds
  v_mfma_f32_4x4x4_16b_bf16 v[96:99], v[112:113], v[176:177], v[96:99]
  v_mfma_f32_4x4x4_16b_bf16 v[104:107], v[176:177], v[176:177], v[104:107]
  v_mfma_f32_4x4x4_16b_bf16 v[100:103], v[112:113], v[178:179], v[100:103]
  v_mfma_f32_4x4x4_16b_bf16 v[108:111], v[178:179], v[178:179], v[108:111]
  v_mfma_f32_4x4x4_16b_bf16 v[96:99], v[112:113], v[180:181], v[96:99]
  v_mfma_f32_4x4x4_16b_bf16 v[104:107], v[180:181], v[180:181], v[104:107]
  v_mfma_f32_4x4x4_16b_bf16 v[100:103], v[112:113], v[182:183], v[100:103]
  v_mfma_f32_4x4x4_16b_bf16 v[108:111], v[182:183], v[182:183], v[108:111]
  v_mfma_f32_4x4x4_16b_bf16 v[96:99], v[112:113], v[184:185], v[96:99]
  v_mfma_f32_4x4x4_16b_bf16 v[104:107], v[184:185], v[184:185], v[104:107]
  v_mfma_f32_4x4x4_16b_bf16 v[100:103], v[112:113], v[186:187], v[100:103]
  v_mfma_f32_4x4x4_16b_bf16 v[108:111], v[186:187], v[186:187], v[108:111]
  v_mfma_f32_4x4x4_16b_bf16 v[96:99], v[112:113], v[188:189], v[96:99]
  v_mfma_f32_4x4x4_16b_bf16 v[104:107], v[188:189], v[188:189], v[104:107]
  v_mfma_f32_4x4x4_16b_bf16 v[100:103], v[112:113], v[190:191], v[100:103]
  v_mfma_f32_4x4x4_16b_bf16 v[108:111], v[190:191], v[190:191], v[108:111]
  s_waitcnt lgkmcnt(0)
  s_waitcnt vmcnt(19)
  s_waitcnt vmcnt(12)
  s_barrier
  v_add_u32 v14, 4294901760, v14
  v_add_u32 v15, 4294901760, v15
  v_add_u32 v16, 4294901760, v16
  v_add_u32 v17, 4294901760, v17
  ds_read_b128 v[208:211], v14 offset:0
  ds_read_b128 v[212:215], v15 offset:0
  ds_read_b128 v[216:219], v16 offset:0
  ds_read_b128 v[220:223], v17 offset:0
  s_add_u32 s80, s65, 2
  s_and_b32 s80, s80, 7
  s_mul_i32 s69, s80, 229376
  s_add_u32 s79, s75, s69
  s_add_u32 m0, s82, 65536
  s_nop 0
  buffer_load_dwordx4 v10, s[12:15], s79 offen offset:0 lds
  buffer_load_dwordx4 v11, s[12:15], s79 offen offset:1024 lds
  s_add_u32 m0, s82, 73728
  s_nop 0
  buffer_load_dwordx4 v12, s[16:19], s79 offen offset:0 lds
  buffer_load_dwordx4 v13, s[16:19], s79 offen offset:1024 lds
  v_mfma_f32_4x4x4_16b_bf16 v[96:99], v[112:113], v[192:193], v[96:99]
  v_mfma_f32_4x4x4_16b_bf16 v[104:107], v[192:193], v[192:193], v[104:107]
  v_mfma_f32_4x4x4_16b_bf16 v[100:103], v[112:113], v[194:195], v[100:103]
  v_mfma_f32_4x4x4_16b_bf16 v[108:111], v[194:195], v[194:195], v[108:111]
  v_mfma_f32_4x4x4_16b_bf16 v[96:99], v[112:113], v[196:197], v[96:99]
  v_mfma_f32_4x4x4_16b_bf16 v[104:107], v[196:197], v[196:197], v[104:107]
  v_mfma_f32_4x4x4_16b_bf16 v[100:103], v[112:113], v[198:199], v[100:103]
  v_mfma_f32_4x4x4_16b_bf16 v[108:111], v[198:199], v[198:199], v[108:111]
  v_mfma_f32_4x4x4_16b_bf16 v[96:99], v[112:113], v[200:201], v[96:99]
  v_mfma_f32_4x4x4_16b_bf16 v[104:107], v[200:201], v[200:201], v[104:107]
  v_mfma_f32_4x4x4_16b_bf16 v[100:103], v[112:113], v[202:203], v[100:103]
  v_mfma_f32_4x4x4_16b_bf16 v[108:111], v[202:203], v[202:203], v[108:111]
  v_mfma_f32_4x4x4_16b_bf16 v[96:99], v[112:113], v[204:205], v[96:99]
  v_mfma_f32_4x4x4_16b_bf16 v[104:107], v[204:205], v[204:205], v[104:107]
  v_mfma_f32_4x4x4_16b_bf16 v[100:103], v[112:113], v[206:207], v[100:103]
  v_mfma_f32_4x4x4_16b_bf16 v[108:111], v[206:207], v[206:207], v[108:111]
  s_waitcnt lgkmcnt(0)
  s_waitcnt vmcnt(14)
  s_barrier
  ds_read_b128 v[224:227], v14 offset:16384
  ds_read_b128 v[228:231], v15 offset:16384
  ds_read_b128 v[232:235], v16 offset:16384
  ds_read_b128 v[236:239], v17 offset:16384
  s_add_u32 s80, s65, 3
  s_and_b32 s80, s80, 7
  s_mul_i32 s69, s80, 229376
  s_add_u32 s79, s75, s69
  s_add_u32 m0, s82, 0
  s_nop 0
  buffer_load_dwordx4 v10, s[12:15], s79 offen offset:0 lds
  buffer_load_dwordx4 v11, s[12:15], s79 offen offset:1024 lds
  s_add_u32 m0, s82, 8192
  s_nop 0
  buffer_load_dwordx4 v12, s[16:19], s79 offen offset:0 lds
  buffer_load_dwordx4 v13, s[16:19], s79 offen offset:1024 lds
  s_add_u32 s80, s65, 4
  s_and_b32 s80, s80, 7
  s_mul_i32 s69, s80, 229376
  s_add_u32 s79, s75, s69
  s_add_u32 m0, s82, 81920
  s_nop 0
  buffer_load_dwordx4 v10, s[12:15], s79 offen offset:0 lds
  buffer_load_dwordx4 v11, s[12:15], s79 offen offset:1024 lds
  s_add_u32 m0, s82, 90112
  s_nop 0
  buffer_load_dwordx4 v12, s[16:19], s79 offen offset:0 lds
  buffer_load_dwordx4 v13, s[16:19], s79 offen offset:1024 lds
  v_mfma_f32_4x4x4_16b_bf16 v[96:99], v[112:113], v[208:209], v[96:99]
  v_mfma_f32_4x4x4_16b_bf16 v[104:107], v[208:209], v[208:209], v[104:107]
  v_mfma_f32_4x4x4_16b_bf16 v[100:103], v[112:113], v[210:211], v[100:103]
  v_mfma_f32_4x4x4_16b_bf16 v[108:111], v[210:211], v[210:211], v[108:111]
  v_mfma_f32_4x4x4_16b_bf16 v[96:99], v[112:113], v[212:213], v[96:99]
  v_mfma_f32_4x4x4_16b_bf16 v[104:107], v[212:213], v[212:213], v[104:107]
  v_mfma_f32_4x4x4_16b_bf16 v[100:103], v[112:113], v[214:215], v[100:103]
  v_mfma_f32_4x4x4_16b_bf16 v[108:111], v[214:215], v[214:215], v[108:111]
  v_mfma_f32_4x4x4_16b_bf16 v[96:99], v[112:113], v[216:217], v[96:99]
  v_mfma_f32_4x4x4_16b_bf16 v[104:107], v[216:217], v[216:217], v[104:107]
  v_mfma_f32_4x4x4_16b_bf16 v[100:103], v[112:113], v[218:219], v[100:103]
  v_mfma_f32_4x4x4_16b_bf16 v[108:111], v[218:219], v[218:219], v[108:111]
  v_mfma_f32_4x4x4_16b_bf16 v[96:99], v[112:113], v[220:221], v[96:99]
  v_mfma_f32_4x4x4_16b_bf16 v[104:107], v[220:221], v[220:221], v[104:107]
  v_mfma_f32_4x4x4_16b_bf16 v[100:103], v[112:113], v[222:223], v[100:103]
  v_mfma_f32_4x4x4_16b_bf16 v[108:111], v[222:223], v[222:223], v[108:111]
  s_waitcnt lgkmcnt(0)
  s_waitcnt vmcnt(18)
  s_waitcnt vmcnt(16)
  s_barrier
  ds_read_b128 v[240:243], v14 offset:32768
  ds_read_b128 v[244:247], v15 offset:32768
  ds_read_b128 v[248:251], v16 offset:32768
  ds_read_b128 v[252:255], v17 offset:32768
  s_add_u32 s80, s65, 5
  s_and_b32 s80, s80, 7
  s_mul_i32 s69, s80, 229376
  s_add_u32 s79, s75, s69
  s_add_u32 m0, s82, 16384
  s_nop 0
  buffer_load_dwordx4 v10, s[12:15], s79 offen offset:0 lds
  buffer_load_dwordx4 v11, s[12:15], s79 offen offset:1024 lds
  s_add_u32 m0, s82, 24576
  s_nop 0
  buffer_load_dwordx4 v12, s[16:19], s79 offen offset:0 lds
  buffer_load_dwordx4 v13, s[16:19], s79 offen offset:1024 lds
  v_mfma_f32_4x4x4_16b_bf16 v[96:99], v[112:113], v[224:225], v[96:99]
  v_mfma_f32_4x4x4_16b_bf16 v[104:107], v[224:225], v[224:225], v[104:107]
  v_mfma_f32_4x4x4_16b_bf16 v[100:103], v[112:113], v[226:227], v[100:103]
  v_mfma_f32_4x4x4_16b_bf16 v[108:111], v[226:227], v[226:227], v[108:111]
  v_mfma_f32_4x4x4_16b_bf16 v[96:99], v[112:113], v[228:229], v[96:99]
  v_mfma_f32_4x4x4_16b_bf16 v[104:107], v[228:229], v[228:229], v[104:107]
  v_mfma_f32_4x4x4_16b_bf16 v[100:103], v[112:113], v[230:231], v[100:103]
  v_mfma_f32_4x4x4_16b_bf16 v[108:111], v[230:231], v[230:231], v[108:111]
  v_mfma_f32_4x4x4_16b_bf16 v[96:99], v[112:113], v[232:233], v[96:99]
  v_mfma_f32_4x4x4_16b_bf16 v[104:107], v[232:233], v[232:233], v[104:107]
  v_mfma_f32_4x4x4_16b_bf16 v[100:103], v[112:113], v[234:235], v[100:103]
  v_mfma_f32_4x4x4_16b_bf16 v[108:111], v[234:235], v[234:235], v[108:111]
  v_mfma_f32_4x4x4_16b_bf16 v[96:99], v[112:113], v[236:237], v[96:99]
  v_mfma_f32_4x4x4_16b_bf16 v[104:107], v[236:237], v[236:237], v[104:107]
  v_mfma_f32_4x4x4_16b_bf16 v[100:103], v[112:113], v[238:239], v[100:103]
  v_mfma_f32_4x4x4_16b_bf16 v[108:111], v[238:239], v[238:239], v[108:111]
  s_waitcnt lgkmcnt(0)
  v_mfma_f32_4x4x4_16b_bf16 v[96:99], v[112:113], v[240:241], v[96:99]
  v_mfma_f32_4x4x4_16b_bf16 v[104:107], v[240:241], v[240:241], v[104:107]
  v_mfma_f32_4x4x4_16b_bf16 v[100:103], v[112:113], v[242:243], v[100:103]
  v_mfma_f32_4x4x4_16b_bf16 v[108:111], v[242:243], v[242:243], v[108:111]
  v_mfma_f32_4x4x4_16b_bf16 v[96:99], v[112:113], v[244:245], v[96:99]
  v_mfma_f32_4x4x4_16b_bf16 v[104:107], v[244:245], v[244:245], v[104:107]
  v_mfma_f32_4x4x4_16b_bf16 v[100:103], v[112:113], v[246:247], v[100:103]
  v_mfma_f32_4x4x4_16b_bf16 v[108:111], v[246:247], v[246:247], v[108:111]
  v_mfma_f32_4x4x4_16b_bf16 v[96:99], v[112:113], v[248:249], v[96:99]
  v_mfma_f32_4x4x4_16b_bf16 v[104:107], v[248:249], v[248:249], v[104:107]
  v_mfma_f32_4x4x4_16b_bf16 v[100:103], v[112:113], v[250:251], v[100:103]
  v_mfma_f32_4x4x4_16b_bf16 v[108:111], v[250:251], v[250:251], v[108:111]
  v_mfma_f32_4x4x4_16b_bf16 v[96:99], v[112:113], v[252:253], v[96:99]
  v_mfma_f32_4x4x4_16b_bf16 v[104:107], v[252:253], v[252:253], v[104:107]
  v_mfma_f32_4x4x4_16b_bf16 v[100:103], v[112:113], v[254:255], v[100:103]
  v_mfma_f32_4x4x4_16b_bf16 v[108:111], v[254:255], v[254:255], v[108:111]
  s_nop 3
  v_add_f32 v32, v96, v100
  v_add_f32 v36, v104, v108
  v_add_f32 v37, v105, v109
  v_add_f32 v38, v106, v110
  v_add_f32 v39, v107, v111
  v_cndmask_b32 v33, v36, v37, s[92:93]
  v_cndmask_b32 v33, v33, v38, s[94:95]
  v_cndmask_b32 v33, v33, v39, s[96:97]
  v_mov_b32 v34, v32
  v_mov_b32 v35, v33
  s_nop 0
  v_permlane32_swap_b32 v32, v34
  v_permlane32_swap_b32 v33, v35
  v_add_f32 v32, v32, v34
  v_add_f32 v33, v33, v35
  v_mul_f32 v32, 0x3b000000, v32
  v_mul_f32 v33, 0x3b000000, v33
  v_fma_f32 v33, -v32, v32, v33
  v_cvt_pk_bf16_f32 v34, v32, v33
  v_lshlrev_b32 v40, 16, v34
  v_and_b32 v35, 0xffff0000, v34
  v_add_f32 v35, 0x3727c5ac, v35
  v_cvt_pk_bf16_f32 v35, v35, v35
  v_and_b32 v35, 0xffff0000, v35
  v_sqrt_f32 v35, v35
  v_bfe_u32 v36, v1, 2, 1
  v_cvt_pk_bf16_f32 v35, v35, v35
  v_and_b32 v35, 0xffff0000, v35
  v_rcp_f32 v41, v35
  v_lshlrev_b32 v36, 4, v36
  v_bfe_u32 v37, v1, 3, 2
  v_lshl_add_u32 v36, v37, 2, v36
  v_and_b32 v37, 3, v1
  v_add_u32 v36, v36, v37
  v_lshrrev_b32 v37, 5, v1
  v_lshlrev_b32 v37, 9, v37
  v_lshl_add_u32 v37, v36, 2, v37
  s_lshl_b32 s69, s62, 7
  s_add_u32 s69, s69, 152576
  v_add_u32 v37, s69, v37
  v_mul_f32 v38, v40, v41
  v_cndmask_b32 v38, v38, v41, s[84:85]
  ds_write_b32 v37, v38
  v_mul_f32 v29, 0xbfb8aa3b, v41
  v_xor_b32 v30, 0x80000000, v40
  v_lshrrev_b32 v39, 16, v30
  v_or_b32 v30, v30, v39
  v_cndmask_b32 v30, 0, v30, s[84:85]
  s_cmp_eq_u32 s64, 0
  s_cbranch_scc0 L_B_nost
  s_lshl_b32 s69, s63, 2
  s_add_u32 s69, s69, s62
  s_lshl_b32 s69, s69, 8
  s_add_u32 s69, s69, 65536
  v_lshlrev_b32 v36, 3, v36
  s_mov_b64 exec, s[84:85]
  buffer_store_dwordx2 v[40:41], v36, s[8:11], s69 offen sc1
  s_mov_b64 exec, -1
L_B_nost:
  s_waitcnt lgkmcnt(0)
  s_barrier
  s_add_u32 s80, s65, 6
  s_and_b32 s80, s80, 7
  s_mul_i32 s69, s80, 229376
  s_add_u32 s79, s75, s69
  s_add_u32 m0, s82, 32768
  s_nop 0
  buffer_load_dwordx4 v10, s[12:15], s79 offen offset:0 lds
  buffer_load_dwordx4 v11, s[12:15], s79 offen offset:1024 lds
  s_add_u32 m0, s82, 40960
  s_nop 0
  buffer_load_dwordx4 v12, s[16:19], s79 offen offset:0 lds
  buffer_load_dwordx4 v13, s[16:19], s79 offen offset:1024 lds
  s_add_u32 s80, s65, 7
  s_and_b32 s80, s80, 7
  s_mul_i32 s69, s80, 229376
  s_add_u32 s79, s75, s69
  s_add_u32 m0, s82, 98304
  s_nop 0
  buffer_load_dwordx4 v10, s[12:15], s79 offen offset:0 lds
  buffer_load_dwordx4 v11, s[12:15], s79 offen offset:1024 lds
  s_add_u32 m0, s82, 106496
  s_nop 0
  buffer_load_dwordx4 v12, s[16:19], s79 offen offset:0 lds
  buffer_load_dwordx4 v13, s[16:19], s79 offen offset:1024 lds
  s_cmp_eq_u32 s62, 1
  s_cselect_b32 s28, s42, s44
  s_cselect_b32 s29, s43, s45
  s_mov_b32 s30, 524288
  s_lshl_b32 s70, s2, 11
  v_and_b32 v9, 15, v1
  s_cmp_eq_u32 s62, 0
  s_cselect_b32 s28, s56, s28
  s_cselect_b32 s29, s57, s29
  s_cselect_b32 s30, 1835008, s30
  s_mov_b32 s31, 0x00020000
  s_mul_i32 s69, s2, 7168
  s_cselect_b32 s70, s69, s70
  s_cselect_b64 vcc, -1, 0
  v_cndmask_b32 v9, v9, v1, vcc
  v_lshlrev_b32 v9, 7, v9
  buffer_load_dword v8, v9, s[28:31], s70 offen
  ds_read_b64_tr_b16 v[96:97], v23 offset:0
  ds_read_b64_tr_b16 v[98:99], v23 offset:512
  ds_read_b64_tr_b16 v[100:101], v24 offset:0
  ds_read_b64_tr_b16 v[102:103], v24 offset:512
  ds_read_b64_tr_b16 v[104:105], v25 offset:0
  ds_read_b64_tr_b16 v[106:107], v25 offset:512
  ds_read_b64_tr_b16 v[108:109], v26 offset:0
  ds_read_b64_tr_b16 v[110:111], v26 offset:512
  ds_read_b64_tr_b16 v[112:113], v23 offset:2048
  ds_read_b64_tr_b16 v[114:115], v23 offset:2560
  s_waitcnt lgkmcnt(8)
  v_mfma_f32_32x32x16_bf16 v[32:47], v[96:99], v[128:131], 0
  ds_read_b64_tr_b16 v[116:117], v24 offset:2048
  ds_read_b64_tr_b16 v[118:119], v24 offset:2560
  s_waitcnt vmcnt(25)
  v_mov_b32 v19, 1
  ds_write_b32 v31, v19
  s_waitcnt lgkmcnt(9)
  v_mfma_f32_32x32x16_bf16 v[48:63], v[100:103], v[128:131], 0
  ds_read_b64_tr_b16 v[120:121], v25 offset:2048
  ds_read_b64_tr_b16 v[122:123], v25 offset:2560
  s_waitcnt lgkmcnt(9)
  v_mfma_f32_32x32x16_bf16 v[64:79], v[104:107], v[128:131], 0
  ds_read_b64_tr_b16 v[124:125], v26 offset:2048
  ds_read_b64_tr_b16 v[126:127], v26 offset:2560
  s_waitcnt lgkmcnt(9)
  v_mfma_f32_32x32x16_bf16 v[80:95], v[108:111], v[128:131], 0
  ds_read_b64_tr_b16 v[96:97], v23 offset:4096
  ds_read_b64_tr_b16 v[98:99], v23 offset:4608
  s_waitcnt lgkmcnt(9)
  v_mfma_f32_32x32x16_bf16 v[32:47], v[112:115], v[132:135], v[32:47]
  ds_read_b64_tr_b16 v[100:101], v24 offset:4096
  ds_read_b64_tr_b16 v[102:103], v24 offset:4608
  s_waitcnt lgkmcnt(9)
  v_mfma_f32_32x32x16_bf16 v[48:63], v[116:119], v[132:135], v[48:63]
  ds_read_b64_tr_b16 v[104:105], v25 offset:4096
  ds_read_b64_tr_b16 v[106:107], v25 offset:4608
  s_waitcnt lgkmcnt(8)
  v_mfma_f32_32x32x16_bf16 v[64:79], v[120:123], v[132:135], v[64:79]
  ds_read_b64_tr_b16 v[108:109], v26 offset:4096
  ds_read_b64_tr_b16 v[110:111], v26 offset:4608
  ds_read_b32 v18, v2 offset:1024
  s_waitcnt lgkmcnt(9)
  v_mfma_f32_32x32x16_bf16 v[80:95], v[124:127], v[132:135], v[80:95]
  ds_read_b64_tr_b16 v[112:113], v23 offset:6144
  ds_read_b64_tr_b16 v[114:115], v23 offset:6656
  s_waitcnt lgkmcnt(9)
  v_mfma_f32_32x32x16_bf16 v[32:47], v[96:99], v[136:139], v[32:47]
  ds_read_b64_tr_b16 v[116:117], v24 offset:6144
  ds_read_b64_tr_b16 v[118:119], v24 offset:6656
  s_waitcnt lgkmcnt(9)
  v_mfma_f32_32x32x16_bf16 v[48:63], v[100:103], v[136:139], v[48:63]
  ds_read_b64_tr_b16 v[120:121], v25 offset:6144
  ds_read_b64_tr_b16 v[122:123], v25 offset:6656
  s_waitcnt lgkmcnt(9)
  v_mfma_f32_32x32x16_bf16 v[64:79], v[104:107], v[136:139], v[64:79]
  ds_read_b64_tr_b16 v[124:125], v26 offset:6144
  ds_read_b64_tr_b16 v[126:127], v26 offset:6656
  s_waitcnt lgkmcnt(9)
  v_mfma_f32_32x32x16_bf16 v[80:95], v[108:111], v[136:139], v[80:95]
  s_waitcnt lgkmcnt(8)
  v_cmp_gt_u32 vcc, 1, v18
  s_cbranch_vccnz L_bl0_s
L_bl0_k:
  v_add_u32 v23, 4294901760, v23
  v_add_u32 v24, 4294901760, v24
  v_add_u32 v25, 4294901760, v25
  v_add_u32 v26, 4294901760, v26
  ds_read_b64_tr_b16 v[96:97], v23 offset:0
  ds_read_b64_tr_b16 v[98:99], v23 offset:512
  s_waitcnt lgkmcnt(8)
  v_mfma_f32_32x32x16_bf16 v[32:47], v[112:115], v[140:143], v[32:47]
  ds_read_b64_tr_b16 v[100:101], v24 offset:0
  ds_read_b64_tr_b16 v[102:103], v24 offset:512
  s_waitcnt lgkmcnt(8)
  v_mfma_f32_32x32x16_bf16 v[48:63], v[116:119], v[140:143], v[48:63]
  ds_read_b64_tr_b16 v[104:105], v25 offset:0
  ds_read_b64_tr_b16 v[106:107], v25 offset:512
  s_waitcnt lgkmcnt(8)
  v_mfma_f32_32x32x16_bf16 v[64:79], v[120:123], v[140:143], v[64:79]
  ds_read_b64_tr_b16 v[108:109], v26 offset:0
  ds_read_b64_tr_b16 v[110:111], v26 offset:512
  s_waitcnt lgkmcnt(8)
  v_mfma_f32_32x32x16_bf16 v[80:95], v[124:127], v[140:143], v[80:95]
  ds_read_b64_tr_b16 v[112:113], v23 offset:2048
  ds_read_b64_tr_b16 v[114:115], v23 offset:2560
  s_waitcnt lgkmcnt(8)
  v_mfma_f32_32x32x16_bf16 v[32:47], v[96:99], v[144:147], v[32:47]
  ds_read_b64_tr_b16 v[116:117], v24 offset:2048
  ds_read_b64_tr_b16 v[118:119], v24 offset:2560
  s_waitcnt vmcnt(21)
  v_mov_b32 v19, 2
  ds_write_b32 v31, v19
  s_waitcnt lgkmcnt(9)
  v_mfma_f32_32x32x16_bf16 v[48:63], v[100:103], v[144:147], v[48:63]
  ds_read_b64_tr_b16 v[120:121], v25 offset:2048
  ds_read_b64_tr_b16 v[122:123], v25 offset:2560
  s_waitcnt lgkmcnt(9)
  v_mfma_f32_32x32x16_bf16 v[64:79], v[104:107], v[144:147], v[64:79]
  ds_read_b64_tr_b16 v[124:125], v26 offset:2048
  ds_read_b64_tr_b16 v[126:127], v26 offset:2560
  s_waitcnt lgkmcnt(9)
  v_mfma_f32_32x32x16_bf16 v[80:95], v[108:111], v[144:147], v[80:95]
  ds_read_b64_tr_b16 v[96:97], v23 offset:4096
  ds_read_b64_tr_b16 v[98:99], v23 offset:4608
  s_waitcnt lgkmcnt(9)
  v_mfma_f32_32x32x16_bf16 v[32:47], v[112:115], v[148:151], v[32:47]
  ds_read_b64_tr_b16 v[100:101], v24 offset:4096
  ds_read_b64_tr_b16 v[102:103], v24 offset:4608
  s_waitcnt lgkmcnt(9)
  v_mfma_f32_32x32x16_bf16 v[48:63], v[116:119], v[148:151], v[48:63]
  ds_read_b64_tr_b16 v[104:105], v25 offset:4096
  ds_read_b64_tr_b16 v[106:107], v25 offset:4608
  s_waitcnt lgkmcnt(8)
  v_mfma_f32_32x32x16_bf16 v[64:79], v[120:123], v[148:151], v[64:79]
  ds_read_b64_tr_b16 v[108:109], v26 offset:4096
  ds_read_b64_tr_b16 v[110:111], v26 offset:4608
  ds_read_b32 v18, v2 offset:1024
  s_waitcnt lgkmcnt(9)
  v_mfma_f32_32x32x16_bf16 v[80:95], v[124:127], v[148:151], v[80:95]
  ds_read_b64_tr_b16 v[112:113], v23 offset:6144
  ds_read_b64_tr_b16 v[114:115], v23 offset:6656
  s_waitcnt lgkmcnt(9)
  v_mfma_f32_32x32x16_bf16 v[32:47], v[96:99], v[152:155], v[32:47]
  ds_read_b64_tr_b16 v[116:117], v24 offset:6144
  ds_read_b64_tr_b16 v[118:119], v24 offset:6656
  s_waitcnt lgkmcnt(9)
  v_mfma_f32_32x32x16_bf16 v[48:63], v[100:103], v[152:155], v[48:63]
  ds_read_b64_tr_b16 v[120:121], v25 offset:6144
  ds_read_b64_tr_b16 v[122:123], v25 offset:6656
  s_waitcnt lgkmcnt(9)
  v_mfma_f32_32x32x16_bf16 v[64:79], v[104:107], v[152:155], v[64:79]
  ds_read_b64_tr_b16 v[124:125], v26 offset:6144
  ds_read_b64_tr_b16 v[126:127], v26 offset:6656
  s_waitcnt lgkmcnt(9)
  v_mfma_f32_32x32x16_bf16 v[80:95], v[108:111], v[152:155], v[80:95]
  s_waitcnt lgkmcnt(8)
  v_cmp_gt_u32 vcc, 2, v18
  s_cbranch_vccnz L_bl1_s
L_bl1_k:
  v_add_u32 v23, 16384, v23
  v_add_u32 v24, 16384, v24
  v_add_u32 v25, 16384, v25
  v_add_u32 v26, 16384, v26
  ds_read_b64_tr_b16 v[96:97], v23 offset:0
  ds_read_b64_tr_b16 v[98:99], v23 offset:512
  s_waitcnt lgkmcnt(8)
  v_mfma_f32_32x32x16_bf16 v[32:47], v[112:115], v[156:159], v[32:47]
  ds_read_b64_tr_b16 v[100:101], v24 offset:0
  ds_read_b64_tr_b16 v[102:103], v24 offset:512
  s_add_u32 s80, s65, 1
  s_and_b32 s80, s80, 7
  s_mul_i32 s69, s80, 229376
  s_add_u32 s79, s76, s69
  s_add_u32 m0, s81, 114688
  s_nop 0
  buffer_load_dwordx4 v20, s[24:27], s79 offen lds
  s_waitcnt lgkmcnt(8)
  v_mfma_f32_32x32x16_bf16 v[48:63], v[116:119], v[156:159], v[48:63]
  ds_read_b64_tr_b16 v[104:105], v25 offset:0
  ds_read_b64_tr_b16 v[106:107], v25 offset:512
  buffer_load_dwordx4 v21, s[24:27], s79 offen offset:1024 lds
  buffer_load_dwordx4 v22, s[24:27], s79 offen offset:2048 lds
  s_waitcnt lgkmcnt(8)
  v_mfma_f32_32x32x16_bf16 v[64:79], v[120:123], v[156:159], v[64:79]
  ds_read_b64_tr_b16 v[108:109], v26 offset:0
  ds_read_b64_tr_b16 v[110:111], v26 offset:512
  s_waitcnt lgkmcnt(8)
  v_mfma_f32_32x32x16_bf16 v[80:95], v[124:127], v[156:159], v[80:95]
  ds_read_b64_tr_b16 v[112:113], v23 offset:2048
  ds_read_b64_tr_b16 v[114:115], v23 offset:2560
  s_waitcnt lgkmcnt(8)
  v_mfma_f32_32x32x16_bf16 v[32:47], v[96:99], v[160:163], v[32:47]
  ds_read_b64_tr_b16 v[116:117], v24 offset:2048
  ds_read_b64_tr_b16 v[118:119], v24 offset:2560
  s_waitcnt vmcnt(20)
  v_mov_b32 v19, 3
  ds_write_b32 v31, v19
  s_waitcnt lgkmcnt(9)
  v_mfma_f32_32x32x16_bf16 v[48:63], v[100:103], v[160:163], v[48:63]
  ds_read_b64_tr_b16 v[120:121], v25 offset:2048
  ds_read_b64_tr_b16 v[122:123], v25 offset:2560
  s_waitcnt lgkmcnt(9)
  v_mfma_f32_32x32x16_bf16 v[64:79], v[104:107], v[160:163], v[64:79]
  ds_read_b64_tr_b16 v[124:125], v26 offset:2048
  ds_read_b64_tr_b16 v[126:127], v26 offset:2560
  s_waitcnt lgkmcnt(9)
  v_mfma_f32_32x32x16_bf16 v[80:95], v[108:111], v[160:163], v[80:95]
  ds_read_b64_tr_b16 v[96:97], v23 offset:4096
  ds_read_b64_tr_b16 v[98:99], v23 offset:4608
  s_waitcnt lgkmcnt(9)
  v_mfma_f32_32x32x16_bf16 v[32:47], v[112:115], v[164:167], v[32:47]
  ds_read_b64_tr_b16 v[100:101], v24 offset:4096
  ds_read_b64_tr_b16 v[102:103], v24 offset:4608
  s_waitcnt lgkmcnt(9)
  v_mfma_f32_32x32x16_bf16 v[48:63], v[116:119], v[164:167], v[48:63]
  ds_read_b64_tr_b16 v[104:105], v25 offset:4096
  ds_read_b64_tr_b16 v[106:107], v25 offset:4608
  s_waitcnt lgkmcnt(8)
  v_mfma_f32_32x32x16_bf16 v[64:79], v[120:123], v[164:167], v[64:79]
  ds_read_b64_tr_b16 v[108:109], v26 offset:4096
  ds_read_b64_tr_b16 v[110:111], v26 offset:4608
  ds_read_b32 v18, v2 offset:1024
  s_waitcnt lgkmcnt(9)
  v_mfma_f32_32x32x16_bf16 v[80:95], v[124:127], v[164:167], v[80:95]
  ds_read_b64_tr_b16 v[112:113], v23 offset:6144
  ds_read_b64_tr_b16 v[114:115], v23 offset:6656
  s_waitcnt lgkmcnt(9)
  v_mfma_f32_32x32x16_bf16 v[32:47], v[96:99], v[168:171], v[32:47]
  ds_read_b64_tr_b16 v[116:117], v24 offset:6144
  ds_read_b64_tr_b16 v[118:119], v24 offset:6656
  s_waitcnt lgkmcnt(9)
  v_mfma_f32_32x32x16_bf16 v[48:63], v[100:103], v[168:171], v[48:63]
  ds_read_b64_tr_b16 v[120:121], v25 offset:6144
  ds_read_b64_tr_b16 v[122:123], v25 offset:6656
  s_waitcnt lgkmcnt(9)
  v_mfma_f32_32x32x16_bf16 v[64:79], v[104:107], v[168:171], v[64:79]
  ds_read_b64_tr_b16 v[124:125], v26 offset:6144
  ds_read_b64_tr_b16 v[126:127], v26 offset:6656
  s_waitcnt lgkmcnt(9)
  v_mfma_f32_32x32x16_bf16 v[80:95], v[108:111], v[168:171], v[80:95]
  s_waitcnt lgkmcnt(8)
  v_cmp_gt_u32 vcc, 3, v18
  s_cbranch_vccnz L_bl2_s
L_bl2_k:
  v_add_u32 v23, 4294901760, v23
  v_add_u32 v24, 4294901760, v24
  v_add_u32 v25, 4294901760, v25
  v_add_u32 v26, 4294901760, v26
  ds_read_b64_tr_b16 v[96:97], v23 offset:0
  ds_read_b64_tr_b16 v[98:99], v23 offset:512
  s_waitcnt lgkmcnt(8)
  v_mfma_f32_32x32x16_bf16 v[32:47], v[112:115], v[172:175], v[32:47]
  ds_read_b64_tr_b16 v[100:101], v24 offset:0
  ds_read_b64_tr_b16 v[102:103], v24 offset:512
  s_add_u32 s80, s65, 2
  s_and_b32 s80, s80, 7
  s_mul_i32 s69, s80, 229376
  s_add_u32 s79, s76, s69
  s_add_u32 m0, s81, 49152
  s_nop 0
  buffer_load_dwordx4 v20, s[24:27], s79 offen lds
  s_waitcnt lgkmcnt(8)
  v_mfma_f32_32x32x16_bf16 v[48:63], v[116:119], v[172:175], v[48:63]
  ds_read_b64_tr_b16 v[104:105], v25 offset:0
  ds_read_b64_tr_b16 v[106:107], v25 offset:512
  buffer_load_dwordx4 v21, s[24:27], s79 offen offset:1024 lds
  buffer_load_dwordx4 v22, s[24:27], s79 offen offset:2048 lds
  s_waitcnt lgkmcnt(8)
  v_mfma_f32_32x32x16_bf16 v[64:79], v[120:123], v[172:175], v[64:79]
  ds_read_b64_tr_b16 v[108:109], v26 offset:0
  ds_read_b64_tr_b16 v[110:111], v26 offset:512
  s_waitcnt lgkmcnt(8)
  v_mfma_f32_32x32x16_bf16 v[80:95], v[124:127], v[172:175], v[80:95]
  ds_read_b64_tr_b16 v[112:113], v23 offset:2048
  ds_read_b64_tr_b16 v[114:115], v23 offset:2560
  s_waitcnt lgkmcnt(8)
  v_mfma_f32_32x32x16_bf16 v[32:47], v[96:99], v[176:179], v[32:47]
  ds_read_b64_tr_b16 v[116:117], v24 offset:2048
  ds_read_b64_tr_b16 v[118:119], v24 offset:2560
  s_waitcnt vmcnt(19)
  v_mov_b32 v19, 4
  ds_write_b32 v31, v19
  s_waitcnt lgkmcnt(9)
  v_mfma_f32_32x32x16_bf16 v[48:63], v[100:103], v[176:179], v[48:63]
  ds_read_b64_tr_b16 v[120:121], v25 offset:2048
  ds_read_b64_tr_b16 v[122:123], v25 offset:2560
  s_waitcnt lgkmcnt(9)
  v_mfma_f32_32x32x16_bf16 v[64:79], v[104:107], v[176:179], v[64:79]
  ds_read_b64_tr_b16 v[124:125], v26 offset:2048
  ds_read_b64_tr_b16 v[126:127], v26 offset:2560
  s_waitcnt lgkmcnt(9)
  v_mfma_f32_32x32x16_bf16 v[80:95], v[108:111], v[176:179], v[80:95]
  ds_read_b64_tr_b16 v[96:97], v23 offset:4096
  ds_read_b64_tr_b16 v[98:99], v23 offset:4608
  s_waitcnt lgkmcnt(9)
  v_mfma_f32_32x32x16_bf16 v[32:47], v[112:115], v[180:183], v[32:47]
  ds_read_b64_tr_b16 v[100:101], v24 offset:4096
  ds_read_b64_tr_b16 v[102:103], v24 offset:4608
  s_waitcnt lgkmcnt(9)
  v_mfma_f32_32x32x16_bf16 v[48:63], v[116:119], v[180:183], v[48:63]
  ds_read_b64_tr_b16 v[104:105], v25 offset:4096
  ds_read_b64_tr_b16 v[106:107], v25 offset:4608
  s_waitcnt lgkmcnt(8)
  v_mfma_f32_32x32x16_bf16 v[64:79], v[120:123], v[180:183], v[64:79]
  ds_read_b64_tr_b16 v[108:109], v26 offset:4096
  ds_read_b64_tr_b16 v[110:111], v26 offset:4608
  ds_read_b32 v18, v2 offset:1024
  s_waitcnt lgkmcnt(9)
  v_mfma_f32_32x32x16_bf16 v[80:95], v[124:127], v[180:183], v[80:95]
  ds_read_b64_tr_b16 v[112:113], v23 offset:6144
  ds_read_b64_tr_b16 v[114:115], v23 offset:6656
  s_waitcnt lgkmcnt(9)
  v_mfma_f32_32x32x16_bf16 v[32:47], v[96:99], v[184:187], v[32:47]
  ds_read_b64_tr_b16 v[116:117], v24 offset:6144
  ds_read_b64_tr_b16 v[118:119], v24 offset:6656
  s_waitcnt lgkmcnt(9)
  v_mfma_f32_32x32x16_bf16 v[48:63], v[100:103], v[184:187], v[48:63]
  ds_read_b64_tr_b16 v[120:121], v25 offset:6144
  ds_read_b64_tr_b16 v[122:123], v25 offset:6656
  s_waitcnt lgkmcnt(9)
  v_mfma_f32_32x32x16_bf16 v[64:79], v[104:107], v[184:187], v[64:79]
  ds_read_b64_tr_b16 v[124:125], v26 offset:6144
  ds_read_b64_tr_b16 v[126:127], v26 offset:6656
  s_waitcnt lgkmcnt(9)
  v_mfma_f32_32x32x16_bf16 v[80:95], v[108:111], v[184:187], v[80:95]
  s_waitcnt lgkmcnt(8)
  v_cmp_gt_u32 vcc, 4, v18
  s_cbranch_vccnz L_bl3_s
L_bl3_k:
  v_add_u32 v23, 81920, v23
  v_add_u32 v24, 81920, v24
  v_add_u32 v25, 81920, v25
  v_add_u32 v26, 81920, v26
  ds_read_b64_tr_b16 v[96:97], v23 offset:0
  ds_read_b64_tr_b16 v[98:99], v23 offset:512
  s_waitcnt lgkmcnt(8)
  v_mfma_f32_32x32x16_bf16 v[32:47], v[112:115], v[188:191], v[32:47]
  ds_read_b64_tr_b16 v[100:101], v24 offset:0
  ds_read_b64_tr_b16 v[102:103], v24 offset:512
  s_add_u32 s80, s65, 3
  s_and_b32 s80, s80, 7
  s_mul_i32 s69, s80, 229376
  s_add_u32 s79, s76, s69
  s_add_u32 m0, s81, 65536
  s_nop 0
  buffer_load_dwordx4 v20, s[24:27], s79 offen lds
  s_waitcnt lgkmcnt(8)
  v_mfma_f32_32x32x16_bf16 v[48:63], v[116:119], v[188:191], v[48:63]
  ds_read_b64_tr_b16 v[104:105], v25 offset:0
  ds_read_b64_tr_b16 v[106:107], v25 offset:512
  buffer_load_dwordx4 v21, s[24:27], s79 offen offset:1024 lds
  buffer_load_dwordx4 v22, s[24:27], s79 offen offset:2048 lds
  s_waitcnt lgkmcnt(8)
  v_mfma_f32_32x32x16_bf16 v[64:79], v[120:123], v[188:191], v[64:79]
  ds_read_b64_tr_b16 v[108:109], v26 offset:0
  ds_read_b64_tr_b16 v[110:111], v26 offset:512
  s_waitcnt lgkmcnt(8)
  v_mfma_f32_32x32x16_bf16 v[80:95], v[124:127], v[188:191], v[80:95]
  ds_read_b64_tr_b16 v[112:113], v23 offset:2048
  ds_read_b64_tr_b16 v[114:115], v23 offset:2560
  s_waitcnt lgkmcnt(8)
  v_mfma_f32_32x32x16_bf16 v[32:47], v[96:99], v[192:195], v[32:47]
  ds_read_b64_tr_b16 v[116:117], v24 offset:2048
  ds_read_b64_tr_b16 v[118:119], v24 offset:2560
  s_waitcnt vmcnt(18)
  v_mov_b32 v19, 5
  ds_write_b32 v31, v19
  s_waitcnt lgkmcnt(9)
  v_mfma_f32_32x32x16_bf16 v[48:63], v[100:103], v[192:195], v[48:63]
  ds_read_b64_tr_b16 v[120:121], v25 offset:2048
  ds_read_b64_tr_b16 v[122:123], v25 offset:2560
  s_waitcnt lgkmcnt(9)
  v_mfma_f32_32x32x16_bf16 v[64:79], v[104:107], v[192:195], v[64:79]
  ds_read_b64_tr_b16 v[124:125], v26 offset:2048
  ds_read_b64_tr_b16 v[126:127], v26 offset:2560
  s_waitcnt lgkmcnt(9)
  v_mfma_f32_32x32x16_bf16 v[80:95], v[108:111], v[192:195], v[80:95]
  ds_read_b64_tr_b16 v[96:97], v23 offset:4096
  ds_read_b64_tr_b16 v[98:99], v23 offset:4608
  s_waitcnt lgkmcnt(9)
  v_mfma_f32_32x32x16_bf16 v[32:47], v[112:115], v[196:199], v[32:47]
  ds_read_b64_tr_b16 v[100:101], v24 offset:4096
  ds_read_b64_tr_b16 v[102:103], v24 offset:4608
  s_waitcnt lgkmcnt(9)
  v_mfma_f32_32x32x16_bf16 v[48:63], v[116:119], v[196:199], v[48:63]
  ds_read_b64_tr_b16 v[104:105], v25 offset:4096
  ds_read_b64_tr_b16 v[106:107], v25 offset:4608
  s_waitcnt lgkmcnt(8)
  v_mfma_f32_32x32x16_bf16 v[64:79], v[120:123], v[196:199], v[64:79]
  ds_read_b64_tr_b16 v[108:109], v26 offset:4096
  ds_read_b64_tr_b16 v[110:111], v26 offset:4608
  ds_read_b32 v18, v2 offset:1024
  s_waitcnt lgkmcnt(9)
  v_mfma_f32_32x32x16_bf16 v[80:95], v[124:127], v[196:199], v[80:95]
  ds_read_b64_tr_b16 v[112:113], v23 offset:6144
  ds_read_b64_tr_b16 v[114:115], v23 offset:6656
  s_waitcnt lgkmcnt(9)
  v_mfma_f32_32x32x16_bf16 v[32:47], v[96:99], v[200:203], v[32:47]
  ds_read_b64_tr_b16 v[116:117], v24 offset:6144
  ds_read_b64_tr_b16 v[118:119], v24 offset:6656
  s_waitcnt lgkmcnt(9)
  v_mfma_f32_32x32x16_bf16 v[48:63], v[100:103], v[200:203], v[48:63]
  ds_read_b64_tr_b16 v[120:121], v25 offset:6144
  ds_read_b64_tr_b16 v[122:123], v25 offset:6656
  s_waitcnt lgkmcnt(9)
  v_mfma_f32_32x32x16_bf16 v[64:79], v[104:107], v[200:203], v[64:79]
  ds_read_b64_tr_b16 v[124:125], v26 offset:6144
  ds_read_b64_tr_b16 v[126:127], v26 offset:6656
  s_waitcnt lgkmcnt(9)
  v_mfma_f32_32x32x16_bf16 v[80:95], v[108:111], v[200:203], v[80:95]
  s_waitcnt lgkmcnt(8)
  v_cmp_gt_u32 vcc, 5, v18
  s_cbranch_vccnz L_bl4_s
L_bl4_k:
  v_add_u32 v23, 4294901760, v23
  v_add_u32 v24, 4294901760, v24
  v_add_u32 v25, 4294901760, v25
  v_add_u32 v26, 4294901760, v26
  ds_read_b64_tr_b16 v[96:97], v23 offset:0
  ds_read_b64_tr_b16 v[98:99], v23 offset:512
  s_waitcnt lgkmcnt(8)
  v_mfma_f32_32x32x16_bf16 v[32:47], v[112:115], v[204:207], v[32:47]
  ds_read_b64_tr_b16 v[100:101], v24 offset:0
  ds_read_b64_tr_b16 v[102:103], v24 offset:512
  s_add_u32 s80, s65, 4
  s_and_b32 s80, s80, 7
  s_mul_i32 s69, s80, 229376
  s_add_u32 s79, s76, s69
  s_add_u32 m0, s81, 0
  s_nop 0
  buffer_load_dwordx4 v20, s[24:27], s79 offen lds
  s_waitcnt lgkmcnt(8)
  v_mfma_f32_32x32x16_bf16 v[48:63], v[116:119], v[204:207], v[48:63]
  ds_read_b64_tr_b16 v[104:105], v25 offset:0
  ds_read_b64_tr_b16 v[106:107], v25 offset:512
  buffer_load_dwordx4 v21, s[24:27], s79 offen offset:1024 lds
  buffer_load_dwordx4 v22, s[24:27], s79 offen offset:2048 lds
  s_waitcnt lgkmcnt(8)
  v_mfma_f32_32x32x16_bf16 v[64:79], v[120:123], v[204:207], v[64:79]
  ds_read_b64_tr_b16 v[108:109], v26 offset:0
  ds_read_b64_tr_b16 v[110:111], v26 offset:512
  s_waitcnt lgkmcnt(8)
  v_mfma_f32_32x32x16_bf16 v[80:95], v[124:127], v[204:207], v[80:95]
  ds_read_b64_tr_b16 v[112:113], v23 offset:2048
  ds_read_b64_tr_b16 v[114:115], v23 offset:2560
  s_waitcnt lgkmcnt(8)
  v_mfma_f32_32x32x16_bf16 v[32:47], v[96:99], v[208:211], v[32:47]
  ds_read_b64_tr_b16 v[116:117], v24 offset:2048
  ds_read_b64_tr_b16 v[118:119], v24 offset:2560
  s_waitcnt vmcnt(17)
  v_mov_b32 v19, 6
  ds_write_b32 v31, v19
  s_waitcnt lgkmcnt(9)
  v_mfma_f32_32x32x16_bf16 v[48:63], v[100:103], v[208:211], v[48:63]
  ds_read_b64_tr_b16 v[120:121], v25 offset:2048
  ds_read_b64_tr_b16 v[122:123], v25 offset:2560
  s_waitcnt lgkmcnt(9)
  v_mfma_f32_32x32x16_bf16 v[64:79], v[104:107], v[208:211], v[64:79]
  ds_read_b64_tr_b16 v[124:125], v26 offset:2048
  ds_read_b64_tr_b16 v[126:127], v26 offset:2560
  s_waitcnt lgkmcnt(9)
  v_mfma_f32_32x32x16_bf16 v[80:95], v[108:111], v[208:211], v[80:95]
  ds_read_b64_tr_b16 v[96:97], v23 offset:4096
  ds_read_b64_tr_b16 v[98:99], v23 offset:4608
  s_waitcnt lgkmcnt(9)
  v_mfma_f32_32x32x16_bf16 v[32:47], v[112:115], v[212:215], v[32:47]
  ds_read_b64_tr_b16 v[100:101], v24 offset:4096
  ds_read_b64_tr_b16 v[102:103], v24 offset:4608
  s_waitcnt lgkmcnt(9)
  v_mfma_f32_32x32x16_bf16 v[48:63], v[116:119], v[212:215], v[48:63]
  ds_read_b64_tr_b16 v[104:105], v25 offset:4096
  ds_read_b64_tr_b16 v[106:107], v25 offset:4608
  s_waitcnt lgkmcnt(8)
  v_mfma_f32_32x32x16_bf16 v[64:79], v[120:123], v[212:215], v[64:79]
  ds_read_b64_tr_b16 v[108:109], v26 offset:4096
  ds_read_b64_tr_b16 v[110:111], v26 offset:4608
  ds_read_b32 v18, v2 offset:1024
  s_waitcnt lgkmcnt(9)
  v_mfma_f32_32x32x16_bf16 v[80:95], v[124:127], v[212:215], v[80:95]
  ds_read_b64_tr_b16 v[112:113], v23 offset:6144
  ds_read_b64_tr_b16 v[114:115], v23 offset:6656
  s_waitcnt lgkmcnt(9)
  v_mfma_f32_32x32x16_bf16 v[32:47], v[96:99], v[216:219], v[32:47]
  ds_read_b64_tr_b16 v[116:117], v24 offset:6144
  ds_read_b64_tr_b16 v[118:119], v24 offset:6656
  s_waitcnt lgkmcnt(9)
  v_mfma_f32_32x32x16_bf16 v[48:63], v[100:103], v[216:219], v[48:63]
  ds_read_b64_tr_b16 v[120:121], v25 offset:6144
  ds_read_b64_tr_b16 v[122:123], v25 offset:6656
  s_waitcnt lgkmcnt(9)
  v_mfma_f32_32x32x16_bf16 v[64:79], v[104:107], v[216:219], v[64:79]
  ds_read_b64_tr_b16 v[124:125], v26 offset:6144
  ds_read_b64_tr_b16 v[126:127], v26 offset:6656
  s_waitcnt lgkmcnt(9)
  v_mfma_f32_32x32x16_bf16 v[80:95], v[108:111], v[216:219], v[80:95]
  s_waitcnt lgkmcnt(8)
  v_cmp_gt_u32 vcc, 6, v18
  s_cbranch_vccnz L_bl5_s
L_bl5_k:
  v_add_u32 v23, 16384, v23
  v_add_u32 v24, 16384, v24
  v_add_u32 v25, 16384, v25
  v_add_u32 v26, 16384, v26
  ds_read_b64_tr_b16 v[96:97], v23 offset:0
  ds_read_b64_tr_b16 v[98:99], v23 offset:512
  s_waitcnt lgkmcnt(8)
  v_mfma_f32_32x32x16_bf16 v[32:47], v[112:115], v[220:223], v[32:47]
  ds_read_b64_tr_b16 v[100:101], v24 offset:0
  ds_read_b64_tr_b16 v[102:103], v24 offset:512
  s_add_u32 s80, s65, 5
  s_and_b32 s80, s80, 7
  s_mul_i32 s69, s80, 229376
  s_add_u32 s79, s76, s69
  s_add_u32 m0, s81, 81920
  s_nop 0
  buffer_load_dwordx4 v20, s[24:27], s79 offen lds
  s_waitcnt lgkmcnt(8)
  v_mfma_f32_32x32x16_bf16 v[48:63], v[116:119], v[220:223], v[48:63]
  ds_read_b64_tr_b16 v[104:105], v25 offset:0
  ds_read_b64_tr_b16 v[106:107], v25 offset:512
  buffer_load_dwordx4 v21, s[24:27], s79 offen offset:1024 lds
  buffer_load_dwordx4 v22, s[24:27], s79 offen offset:2048 lds
  s_waitcnt lgkmcnt(8)
  v_mfma_f32_32x32x16_bf16 v[64:79], v[120:123], v[220:223], v[64:79]
  ds_read_b64_tr_b16 v[108:109], v26 offset:0
  ds_read_b64_tr_b16 v[110:111], v26 offset:512
  s_waitcnt lgkmcnt(8)
  v_mfma_f32_32x32x16_bf16 v[80:95], v[124:127], v[220:223], v[80:95]
  ds_read_b64_tr_b16 v[112:113], v23 offset:2048
  ds_read_b64_tr_b16 v[114:115], v23 offset:2560
  s_waitcnt lgkmcnt(8)
  v_mfma_f32_32x32x16_bf16 v[32:47], v[96:99], v[224:227], v[32:47]
  ds_read_b64_tr_b16 v[116:117], v24 offset:2048
  ds_read_b64_tr_b16 v[118:119], v24 offset:2560
  s_waitcnt vmcnt(16)
  v_mov_b32 v19, 7
  ds_write_b32 v31, v19
  s_waitcnt lgkmcnt(9)
  v_mfma_f32_32x32x16_bf16 v[48:63], v[100:103], v[224:227], v[48:63]
  ds_read_b64_tr_b16 v[120:121], v25 offset:2048
  ds_read_b64_tr_b16 v[122:123], v25 offset:2560
  s_waitcnt lgkmcnt(9)
  v_mfma_f32_32x32x16_bf16 v[64:79], v[104:107], v[224:227], v[64:79]
  ds_read_b64_tr_b16 v[124:125], v26 offset:2048
  ds_read_b64_tr_b16 v[126:127], v26 offset:2560
  s_waitcnt lgkmcnt(9)
  v_mfma_f32_32x32x16_bf16 v[80:95], v[108:111], v[224:227], v[80:95]
  ds_read_b64_tr_b16 v[96:97], v23 offset:4096
  ds_read_b64_tr_b16 v[98:99], v23 offset:4608
  s_waitcnt lgkmcnt(9)
  v_mfma_f32_32x32x16_bf16 v[32:47], v[112:115], v[228:231], v[32:47]
  ds_read_b64_tr_b16 v[100:101], v24 offset:4096
  ds_read_b64_tr_b16 v[102:103], v24 offset:4608
  s_waitcnt lgkmcnt(9)
  v_mfma_f32_32x32x16_bf16 v[48:63], v[116:119], v[228:231], v[48:63]
  ds_read_b64_tr_b16 v[104:105], v25 offset:4096
  ds_read_b64_tr_b16 v[106:107], v25 offset:4608
  s_waitcnt lgkmcnt(8)
  v_mfma_f32_32x32x16_bf16 v[64:79], v[120:123], v[228:231], v[64:79]
  ds_read_b64_tr_b16 v[108:109], v26 offset:4096
  ds_read_b64_tr_b16 v[110:111], v26 offset:4608
  ds_read_b32 v18, v2 offset:1024
  s_waitcnt lgkmcnt(9)
  v_mfma_f32_32x32x16_bf16 v[80:95], v[124:127], v[228:231], v[80:95]
  ds_read_b64_tr_b16 v[112:113], v23 offset:6144
  ds_read_b64_tr_b16 v[114:115], v23 offset:6656
  s_waitcnt lgkmcnt(9)
  v_mfma_f32_32x32x16_bf16 v[32:47], v[96:99], v[232:235], v[32:47]
  ds_read_b64_tr_b16 v[116:117], v24 offset:6144
  ds_read_b64_tr_b16 v[118:119], v24 offset:6656
  s_waitcnt lgkmcnt(9)
  v_mfma_f32_32x32x16_bf16 v[48:63], v[100:103], v[232:235], v[48:63]
  ds_read_b64_tr_b16 v[120:121], v25 offset:6144
  ds_read_b64_tr_b16 v[122:123], v25 offset:6656
  s_waitcnt lgkmcnt(9)
  v_mfma_f32_32x32x16_bf16 v[64:79], v[104:107], v[232:235], v[64:79]
  ds_read_b64_tr_b16 v[124:125], v26 offset:6144
  ds_read_b64_tr_b16 v[126:127], v26 offset:6656
  s_waitcnt lgkmcnt(9)
  v_mfma_f32_32x32x16_bf16 v[80:95], v[108:111], v[232:235], v[80:95]
  s_waitcnt lgkmcnt(8)
  v_cmp_gt_u32 vcc, 7, v18
  s_cbranch_vccnz L_bl6_s
L_bl6_k:
  v_add_u32 v23, 65536, v23
  v_add_u32 v24, 65536, v24
  v_add_u32 v25, 65536, v25
  v_add_u32 v26, 65536, v26
  ds_read_b64_tr_b16 v[96:97], v23 offset:0
  ds_read_b64_tr_b16 v[98:99], v23 offset:512
  s_waitcnt lgkmcnt(8)
  v_mfma_f32_32x32x16_bf16 v[32:47], v[112:115], v[236:239], v[32:47]
  ds_read_b64_tr_b16 v[100:101], v24 offset:0
  ds_read_b64_tr_b16 v[102:103], v24 offset:512
  s_add_u32 s80, s65, 6
  s_and_b32 s80, s80, 7
  s_mul_i32 s69, s80, 229376
  s_add_u32 s79, s76, s69
  s_add_u32 m0, s81, 16384
  s_nop 0
  buffer_load_dwordx4 v20, s[24:27], s79 offen lds
  s_waitcnt lgkmcnt(8)
  v_mfma_f32_32x32x16_bf16 v[48:63], v[116:119], v[236:239], v[48:63]
  ds_read_b64_tr_b16 v[104:105], v25 offset:0
  ds_read_b64_tr_b16 v[106:107], v25 offset:512
  buffer_load_dwordx4 v21, s[24:27], s79 offen offset:1024 lds
  buffer_load_dwordx4 v22, s[24:27], s79 offen offset:2048 lds
  s_waitcnt lgkmcnt(8)
  v_mfma_f32_32x32x16_bf16 v[64:79], v[120:123], v[236:239], v[64:79]
  ds_read_b64_tr_b16 v[108:109], v26 offset:0
  ds_read_b64_tr_b16 v[110:111], v26 offset:512
  s_waitcnt lgkmcnt(8)
  v_mfma_f32_32x32x16_bf16 v[80:95], v[124:127], v[236:239], v[80:95]
  ds_read_b64_tr_b16 v[112:113], v23 offset:2048
  ds_read_b64_tr_b16 v[114:115], v23 offset:2560
  s_waitcnt lgkmcnt(8)
  v_mfma_f32_32x32x16_bf16 v[32:47], v[96:99], v[240:243], v[32:47]
  ds_read_b64_tr_b16 v[116:117], v24 offset:2048
  ds_read_b64_tr_b16 v[118:119], v24 offset:2560
  v_mov_b32 v19, 8
  ds_write_b32 v31, v19
  s_waitcnt lgkmcnt(9)
  v_mfma_f32_32x32x16_bf16 v[48:63], v[100:103], v[240:243], v[48:63]
  ds_read_b64_tr_b16 v[120:121], v25 offset:2048
  ds_read_b64_tr_b16 v[122:123], v25 offset:2560
  s_waitcnt lgkmcnt(9)
  v_mfma_f32_32x32x16_bf16 v[64:79], v[104:107], v[240:243], v[64:79]
  ds_read_b64_tr_b16 v[124:125], v26 offset:2048
  ds_read_b64_tr_b16 v[126:127], v26 offset:2560
  s_waitcnt lgkmcnt(9)
  v_mfma_f32_32x32x16_bf16 v[80:95], v[108:111], v[240:243], v[80:95]
  ds_read_b64_tr_b16 v[96:97], v23 offset:4096
  ds_read_b64_tr_b16 v[98:99], v23 offset:4608
  s_waitcnt lgkmcnt(9)
  v_mfma_f32_32x32x16_bf16 v[32:47], v[112:115], v[244:247], v[32:47]
  ds_read_b64_tr_b16 v[100:101], v24 offset:4096
  ds_read_b64_tr_b16 v[102:103], v24 offset:4608
  s_waitcnt lgkmcnt(9)
  v_mfma_f32_32x32x16_bf16 v[48:63], v[116:119], v[244:247], v[48:63]
  ds_read_b64_tr_b16 v[104:105], v25 offset:4096
  ds_read_b64_tr_b16 v[106:107], v25 offset:4608
  s_waitcnt lgkmcnt(8)
  v_mfma_f32_32x32x16_bf16 v[64:79], v[120:123], v[244:247], v[64:79]
  ds_read_b64_tr_b16 v[108:109], v26 offset:4096
  ds_read_b64_tr_b16 v[110:111], v26 offset:4608
  ds_read_b32 v18, v2 offset:1024
  s_waitcnt lgkmcnt(9)
  v_mfma_f32_32x32x16_bf16 v[80:95], v[124:127], v[244:247], v[80:95]
  ds_read_b64_tr_b16 v[112:113], v23 offset:6144
  ds_read_b64_tr_b16 v[114:115], v23 offset:6656
  s_waitcnt lgkmcnt(9)
  v_mfma_f32_32x32x16_bf16 v[32:47], v[96:99], v[248:251], v[32:47]
  ds_read_b64_tr_b16 v[116:117], v24 offset:6144
  ds_read_b64_tr_b16 v[118:119], v24 offset:6656
  s_waitcnt lgkmcnt(9)
  v_mfma_f32_32x32x16_bf16 v[48:63], v[100:103], v[248:251], v[48:63]
  ds_read_b64_tr_b16 v[120:121], v25 offset:6144
  ds_read_b64_tr_b16 v[122:123], v25 offset:6656
  s_waitcnt lgkmcnt(9)
  v_mfma_f32_32x32x16_bf16 v[64:79], v[104:107], v[248:251], v[64:79]
  ds_read_b64_tr_b16 v[124:125], v26 offset:6144
  ds_read_b64_tr_b16 v[126:127], v26 offset:6656
  s_waitcnt lgkmcnt(9)
  v_mfma_f32_32x32x16_bf16 v[80:95], v[108:111], v[248:251], v[80:95]
  s_waitcnt lgkmcnt(8)
  v_cmp_gt_u32 vcc, 8, v18
  s_cbranch_vccnz L_bl7_s
L_bl7_k:
  s_waitcnt lgkmcnt(6)
  v_mfma_f32_32x32x16_bf16 v[32:47], v[112:115], v[252:255], v[32:47]
  s_add_u32 s80, s65, 7
  s_and_b32 s80, s80, 7
  s_mul_i32 s69, s80, 229376
  s_add_u32 s79, s76, s69
  s_add_u32 m0, s81, 32768
  s_nop 0
  buffer_load_dwordx4 v20, s[24:27], s79 offen lds
  s_waitcnt lgkmcnt(4)
  v_mfma_f32_32x32x16_bf16 v[48:63], v[116:119], v[252:255], v[48:63]
  buffer_load_dwordx4 v21, s[24:27], s79 offen offset:1024 lds
  buffer_load_dwordx4 v22, s[24:27], s79 offen offset:2048 lds
  s_waitcnt lgkmcnt(2)
  v_mfma_f32_32x32x16_bf16 v[64:79], v[120:123], v[252:255], v[64:79]
  s_waitcnt lgkmcnt(0)
  v_mfma_f32_32x32x16_bf16 v[80:95], v[124:127], v[252:255], v[80:95]
  ds_read_b32 v18, v2 offset:0
  s_waitcnt lgkmcnt(0)
  v_cmp_gt_u32 vcc, 2, v18
  s_cbranch_vccnz L_bcs_s
L_bcs_k:
  v_and_b32 v18, 31, v1
  v_lshlrev_b32 v18, 3, v18
  v_add_u32 v18, 154624, v18
  ds_read_b64 v[96:97], v18 offset:0
  ds_read_b64 v[100:101], v18 offset:256
  ds_read_b64 v[104:105], v18 offset:512
  ds_read_b64 v[108:109], v18 offset:768
  v_mov_b32 v98, 0
  v_mov_b32 v99, 0
  v_mov_b32 v102, 0
  v_mov_b32 v103, 0
  v_mov_b32 v106, 0
  v_mov_b32 v107, 0
  v_mov_b32 v110, 0
  v_mov_b32 v111, 0
  v_mov_b32 v112, v30
  v_lshrrev_b32 v113, 16, v30
  v_mov_b32 v114, 0
  v_mov_b32 v115, 0
  s_waitcnt vmcnt(3)
  s_waitcnt lgkmcnt(0)
  v_mov_b32 v19, 9
  ds_write_b32 v31, v19
  v_mfma_f32_32x32x16_bf16 v[32:47], v[96:99], v[112:115], v[32:47]
  v_mfma_f32_32x32x16_bf16 v[48:63], v[100:103], v[112:115], v[48:63]
  v_mfma_f32_32x32x16_bf16 v[64:79], v[104:107], v[112:115], v[64:79]
  v_mfma_f32_32x32x16_bf16 v[80:95], v[108:111], v[112:115], v[80:95]
  s_nop 8
  v_mul_f32 v18, v32, v29
  v_mul_f32 v19, v33, v29
  v_exp_f32 v18, v18
  v_exp_f32 v19, v19
  v_mul_f32 v32, v32, v40
  v_mul_f32 v33, v33, v41
  v_add_f32 v18, 1.0, v18
  v_add_f32 v19, 1.0, v19
  v_rcp_f32 v18, v18
  v_rcp_f32 v19, v19
  v_mul_f32 v32, v32, v18
  v_mul_f32 v33, v33, v19
  v_cvt_pk_bf16_f32 v40, v32, v33
  v_mul_f32 v18, v34, v29
  v_mul_f32 v19, v35, v29
  v_exp_f32 v18, v18
  v_exp_f32 v19, v19
  v_mul_f32 v34, v34, v42
  v_mul_f32 v35, v35, v43
  v_add_f32 v18, 1.0, v18
  v_add_f32 v19, 1.0, v19
  v_rcp_f32 v18, v18
  v_rcp_f32 v19, v19
  v_mul_f32 v34, v34, v18
  v_mul_f32 v35, v35, v19
  v_cvt_pk_bf16_f32 v41, v34, v35
  v_mul_f32 v18, v36, v29
  v_mul_f32 v19, v37, v29
  v_exp_f32 v18, v18
  v_exp_f32 v19, v19
  v_mul_f32 v36, v36, v44
  v_mul_f32 v37, v37, v45
  v_add_f32 v18, 1.0, v18
  v_add_f32 v19, 1.0, v19
  v_rcp_f32 v18, v18
  v_rcp_f32 v19, v19
  v_mul_f32 v36, v36, v18
  v_mul_f32 v37, v37, v19
  v_cvt_pk_bf16_f32 v42, v36, v37
  v_mul_f32 v18, v38, v29
  v_mul_f32 v19, v39, v29
  v_exp_f32 v18, v18
  v_exp_f32 v19, v19
  v_mul_f32 v38, v38, v46
  v_mul_f32 v39, v39, v47
  v_add_f32 v18, 1.0, v18
  v_add_f32 v19, 1.0, v19
  v_rcp_f32 v18, v18
  v_rcp_f32 v19, v19
  v_mul_f32 v38, v38, v18
  v_mul_f32 v39, v39, v19
  v_cvt_pk_bf16_f32 v43, v38, v39
  buffer_store_dwordx4 v[40:43], v28, s[8:11], s88 offen offset:0 sc1
  v_mul_f32 v18, v48, v29
  v_mul_f32 v19, v49, v29
  v_exp_f32 v18, v18
  v_exp_f32 v19, v19
  v_mul_f32 v48, v48, v56
  v_mul_f32 v49, v49, v57
  v_add_f32 v18, 1.0, v18
  v_add_f32 v19, 1.0, v19
  v_rcp_f32 v18, v18
  v_rcp_f32 v19, v19
  v_mul_f32 v48, v48, v18
  v_mul_f32 v49, v49, v19
  v_cvt_pk_bf16_f32 v56, v48, v49
  v_mul_f32 v18, v50, v29
  v_mul_f32 v19, v51, v29
  v_exp_f32 v18, v18
  v_exp_f32 v19, v19
  v_mul_f32 v50, v50, v58
  v_mul_f32 v51, v51, v59
  v_add_f32 v18, 1.0, v18
  v_add_f32 v19, 1.0, v19
  v_rcp_f32 v18, v18
  v_rcp_f32 v19, v19
  v_mul_f32 v50, v50, v18
  v_mul_f32 v51, v51, v19
  v_cvt_pk_bf16_f32 v57, v50, v51
  v_mul_f32 v18, v52, v29
  v_mul_f32 v19, v53, v29
  v_exp_f32 v18, v18
  v_exp_f32 v19, v19
  v_mul_f32 v52, v52, v60
  v_mul_f32 v53, v53, v61
  v_add_f32 v18, 1.0, v18
  v_add_f32 v19, 1.0, v19
  v_rcp_f32 v18, v18
  v_rcp_f32 v19, v19
  v_mul_f32 v52, v52, v18
  v_mul_f32 v53, v53, v19
  v_cvt_pk_bf16_f32 v58, v52, v53
  v_mul_f32 v18, v54, v29
  v_mul_f32 v19, v55, v29
  v_exp_f32 v18, v18
  v_exp_f32 v19, v19
  v_mul_f32 v54, v54, v62
  v_mul_f32 v55, v55, v63
  v_add_f32 v18, 1.0, v18
  v_add_f32 v19, 1.0, v19
  v_rcp_f32 v18, v18
  v_rcp_f32 v19, v19
  v_mul_f32 v54, v54, v18
  v_mul_f32 v55, v55, v19
  v_cvt_pk_bf16_f32 v59, v54, v55
  buffer_store_dwordx4 v[56:59], v28, s[8:11], s88 offen offset:1024 sc1
  v_mul_f32 v18, v64, v29
  v_mul_f32 v19, v65, v29
  v_exp_f32 v18, v18
  v_exp_f32 v19, v19
  v_mul_f32 v64, v64, v72
  v_mul_f32 v65, v65, v73
  v_add_f32 v18, 1.0, v18
  v_add_f32 v19, 1.0, v19
  v_rcp_f32 v18, v18
  v_rcp_f32 v19, v19
  v_mul_f32 v64, v64, v18
  v_mul_f32 v65, v65, v19
  v_cvt_pk_bf16_f32 v72, v64, v65
  v_mul_f32 v18, v66, v29
  v_mul_f32 v19, v67, v29
  v_exp_f32 v18, v18
  v_exp_f32 v19, v19
  v_mul_f32 v66, v66, v74
  v_mul_f32 v67, v67, v75
  v_add_f32 v18, 1.0, v18
  v_add_f32 v19, 1.0, v19
  v_rcp_f32 v18, v18
  v_rcp_f32 v19, v19
  v_mul_f32 v66, v66, v18
  v_mul_f32 v67, v67, v19
  v_cvt_pk_bf16_f32 v73, v66, v67
  v_mul_f32 v18, v68, v29
  v_mul_f32 v19, v69, v29
  v_exp_f32 v18, v18
  v_exp_f32 v19, v19
  v_mul_f32 v68, v68, v76
  v_mul_f32 v69, v69, v77
  v_add_f32 v18, 1.0, v18
  v_add_f32 v19, 1.0, v19
  v_rcp_f32 v18, v18
  v_rcp_f32 v19, v19
  v_mul_f32 v68, v68, v18
  v_mul_f32 v69, v69, v19
  v_cvt_pk_bf16_f32 v74, v68, v69
  v_mul_f32 v18, v70, v29
  v_mul_f32 v19, v71, v29
  v_exp_f32 v18, v18
  v_exp_f32 v19, v19
  v_mul_f32 v70, v70, v78
  v_mul_f32 v71, v71, v79
  v_add_f32 v18, 1.0, v18
  v_add_f32 v19, 1.0, v19
  v_rcp_f32 v18, v18
  v_rcp_f32 v19, v19
  v_mul_f32 v70, v70, v18
  v_mul_f32 v71, v71, v19
  v_cvt_pk_bf16_f32 v75, v70, v71
  buffer_store_dwordx4 v[72:75], v28, s[8:11], s88 offen offset:2048 sc1
  v_mul_f32 v18, v80, v29
  v_mul_f32 v19, v81, v29
  v_exp_f32 v18, v18
  v_exp_f32 v19, v19
  v_mul_f32 v80, v80, v88
  v_mul_f32 v81, v81, v89
  v_add_f32 v18, 1.0, v18
  v_add_f32 v19, 1.0, v19
  v_rcp_f32 v18, v18
  v_rcp_f32 v19, v19
  v_mul_f32 v80, v80, v18
  v_mul_f32 v81, v81, v19
  v_cvt_pk_bf16_f32 v88, v80, v81
  v_mul_f32 v18, v82, v29
  v_mul_f32 v19, v83, v29
  v_exp_f32 v18, v18
  v_exp_f32 v19, v19
  v_mul_f32 v82, v82, v90
  v_mul_f32 v83, v83, v91
  v_add_f32 v18, 1.0, v18
  v_add_f32 v19, 1.0, v19
  v_rcp_f32 v18, v18
  v_rcp_f32 v19, v19
  v_mul_f32 v82, v82, v18
  v_mul_f32 v83, v83, v19
  v_cvt_pk_bf16_f32 v89, v82, v83
  v_mul_f32 v18, v84, v29
  v_mul_f32 v19, v85, v29
  v_exp_f32 v18, v18
  v_exp_f32 v19, v19
  v_mul_f32 v84, v84, v92
  v_mul_f32 v85, v85, v93
  v_add_f32 v18, 1.0, v18
  v_add_f32 v19, 1.0, v19
  v_rcp_f32 v18, v18
  v_rcp_f32 v19, v19
  v_mul_f32 v84, v84, v18
  v_mul_f32 v85, v85, v19
  v_cvt_pk_bf16_f32 v90, v84, v85
  v_mul_f32 v18, v86, v29
  v_mul_f32 v19, v87, v29
  v_exp_f32 v18, v18
  v_exp_f32 v19, v19
  v_mul_f32 v86, v86, v94
  v_mul_f32 v87, v87, v95
  v_add_f32 v18, 1.0, v18
  v_add_f32 v19, 1.0, v19
  v_rcp_f32 v18, v18
  v_rcp_f32 v19, v19
  v_mul_f32 v86, v86, v18
  v_mul_f32 v87, v87, v19
  v_cvt_pk_bf16_f32 v91, v86, v87
  buffer_store_dwordx4 v[88:91], v28, s[8:11], s88 offen offset:3072 sc1
  ds_read_b64_tr_b16 v[96:97], v27 offset:0
  ds_read_b64_tr_b16 v[98:99], v27 offset:384
  ds_read_b64_tr_b16 v[100:101], v27 offset:32
  ds_read_b64_tr_b16 v[102:103], v27 offset:416
  ds_read_b64_tr_b16 v[104:105], v27 offset:64
  ds_read_b64_tr_b16 v[106:107], v27 offset:448
  ds_read_b64_tr_b16 v[108:109], v27 offset:1536
  ds_read_b64_tr_b16 v[110:111], v27 offset:1920
  ds_read_b64_tr_b16 v[112:113], v27 offset:1568
  ds_read_b64_tr_b16 v[114:115], v27 offset:1952
  s_waitcnt lgkmcnt(8)
  v_mfma_f32_32x32x16_bf16 v[32:47], v[96:99], v[128:131], 0
  ds_read_b64_tr_b16 v[116:117], v27 offset:1600
  ds_read_b64_tr_b16 v[118:119], v27 offset:1984
  s_waitcnt lgkmcnt(8)
  v_mfma_f32_32x32x16_bf16 v[48:63], v[100:103], v[128:131], 0
  ds_read_b64_tr_b16 v[120:121], v27 offset:3072
  ds_read_b64_tr_b16 v[122:123], v27 offset:3456
  s_waitcnt lgkmcnt(8)
  v_mfma_f32_32x32x16_bf16 v[64:79], v[104:107], v[128:131], 0
  ds_read_b64_tr_b16 v[124:125], v27 offset:3104
  ds_read_b64_tr_b16 v[126:127], v27 offset:3488
  ds_read_b32 v18, v2 offset:1024
  s_and_b32 s73, s62, 1
  s_lshr_b32 s74, s62, 1
  s_waitcnt lgkmcnt(9)
  v_mfma_f32_32x32x16_bf16 v[32:47], v[108:111], v[132:135], v[32:47]
  ds_read_b64_tr_b16 v[96:97], v27 offset:3136
  ds_read_b64_tr_b16 v[98:99], v27 offset:3520
  s_lshl_b32 s69, s73, 13
  s_add_u32 s69, s69, 2048
  s_waitcnt lgkmcnt(9)
  v_mfma_f32_32x32x16_bf16 v[48:63], v[112:115], v[132:135], v[48:63]
  ds_read_b64_tr_b16 v[100:101], v27 offset:4608
  ds_read_b64_tr_b16 v[102:103], v27 offset:4992
  v_add_u32 v92, s69, v28
  v_add_u32 v93, 0x10000, v92
  s_waitcnt lgkmcnt(9)
  v_mfma_f32_32x32x16_bf16 v[64:79], v[116:119], v[132:135], v[64:79]
  ds_read_b64_tr_b16 v[104:105], v27 offset:4640
  ds_read_b64_tr_b16 v[106:107], v27 offset:5024
  v_add_u32 v94, 0x20000, v92
  v_lshrrev_b32 v14, 5, v1
  s_waitcnt lgkmcnt(9)
  v_mfma_f32_32x32x16_bf16 v[32:47], v[120:123], v[136:139], v[32:47]
  ds_read_b64_tr_b16 v[108:109], v27 offset:4672
  ds_read_b64_tr_b16 v[110:111], v27 offset:5056
  v_bfe_u32 v15, v1, 4, 1
  v_bfe_u32 v16, v1, 2, 2
  s_waitcnt lgkmcnt(9)
  v_mfma_f32_32x32x16_bf16 v[48:63], v[124:127], v[136:139], v[48:63]
  s_waitcnt lgkmcnt(8)
  v_cmp_gt_u32 vcc, 9, v18
  s_cbranch_vccnz L_br0_s
L_br0_k:
  v_add_u32 v27, 4294950912, v27
  ds_read_b64_tr_b16 v[112:113], v27 offset:0
  ds_read_b64_tr_b16 v[114:115], v27 offset:384
  v_and_b32 v17, 3, v1
  v_lshlrev_b32 v20, 2, v14
  s_waitcnt lgkmcnt(8)
  v_mfma_f32_32x32x16_bf16 v[64:79], v[96:99], v[136:139], v[64:79]
  ds_read_b64_tr_b16 v[116:117], v27 offset:32
  ds_read_b64_tr_b16 v[118:119], v27 offset:416
  v_add_u32 v20, v20, v16
  v_lshlrev_b32 v20, 7, v20
  s_waitcnt lgkmcnt(8)
  v_mfma_f32_32x32x16_bf16 v[32:47], v[100:103], v[140:143], v[32:47]
  ds_read_b64_tr_b16 v[120:121], v27 offset:64
  ds_read_b64_tr_b16 v[122:123], v27 offset:448
  v_lshlrev_b32 v21, 5, v15
  v_lshlrev_b32 v22, 3, v17
  s_waitcnt lgkmcnt(8)
  v_mfma_f32_32x32x16_bf16 v[48:63], v[104:107], v[140:143], v[48:63]
  ds_read_b64_tr_b16 v[124:125], v27 offset:1536
  ds_read_b64_tr_b16 v[126:127], v27 offset:1920
  v_add_u32 v21, v21, v22
  s_lshl_b32 s70, s74, 6
  s_waitcnt lgkmcnt(8)
  v_mfma_f32_32x32x16_bf16 v[64:79], v[108:111], v[140:143], v[64:79]
  ds_read_b64_tr_b16 v[96:97], v27 offset:1568
  ds_read_b64_tr_b16 v[98:99], v27 offset:1952
  v_add_u32 v21, s70, v21
  v_bfe_u32 v22, v16, 1, 1
  s_waitcnt lgkmcnt(8)
  v_mfma_f32_32x32x16_bf16 v[32:47], v[112:115], v[144:147], v[32:47]
  ds_read_b64_tr_b16 v[100:101], v27 offset:1600
  ds_read_b64_tr_b16 v[102:103], v27 offset:1984
  s_waitcnt vmcnt(4)
  v_mov_b32 v19, 10
  ds_write_b32 v31, v19
  v_lshlrev_b32 v22, 6, v22
  v_xor_b32 v21, v21, v22
  s_waitcnt lgkmcnt(9)
  v_mfma_f32_32x32x16_bf16 v[48:63], v[116:119], v[144:147], v[48:63]
  ds_read_b64_tr_b16 v[104:105], v27 offset:3072
  ds_read_b64_tr_b16 v[106:107], v27 offset:3456
  v_add_u32 v4, v20, v21
  v_add_u32 v5, 0x10000, v4
  s_waitcnt lgkmcnt(9)
  v_mfma_f32_32x32x16_bf16 v[64:79], v[120:123], v[144:147], v[64:79]
  ds_read_b64_tr_b16 v[108:109], v27 offset:3104
  ds_read_b64_tr_b16 v[110:111], v27 offset:3488
  v_add_u32 v6, 0x20000, v4
  v_lshlrev_b32 v20, 9, v14
  s_waitcnt lgkmcnt(9)
  v_mfma_f32_32x32x16_bf16 v[32:47], v[124:127], v[148:151], v[32:47]
  ds_read_b64_tr_b16 v[112:113], v27 offset:3136
  ds_read_b64_tr_b16 v[114:115], v27 offset:3520
  v_lshl_add_u32 v20, v15, 7, v20
  v_lshl_add_u32 v20, v16, 4, v20
  s_waitcnt lgkmcnt(9)
  v_mfma_f32_32x32x16_bf16 v[48:63], v[96:99], v[148:151], v[48:63]
  ds_read_b64_tr_b16 v[116:117], v27 offset:4608
  ds_read_b64_tr_b16 v[118:119], v27 offset:4992
  v_and_b32 v21, 1, v17
  v_lshl_add_u32 v20, v21, 6, v20
  s_waitcnt lgkmcnt(9)
  v_mfma_f32_32x32x16_bf16 v[64:79], v[100:103], v[148:151], v[64:79]
  ds_read_b64_tr_b16 v[120:121], v27 offset:4640
  ds_read_b64_tr_b16 v[122:123], v27 offset:5024
  v_lshrrev_b32 v21, 1, v17
  v_lshl_add_u32 v20, v21, 3, v20
  s_waitcnt lgkmcnt(8)
  v_mfma_f32_32x32x16_bf16 v[32:47], v[104:107], v[152:155], v[32:47]
  ds_read_b64_tr_b16 v[124:125], v27 offset:4672
  ds_read_b64_tr_b16 v[126:127], v27 offset:5056
  v_add_u32 v7, s69, v20
  v_add_u32 v8, 0x10000, v7
  s_waitcnt lgkmcnt(8)
  v_mfma_f32_32x32x16_bf16 v[48:63], v[108:111], v[152:155], v[48:63]
  v_add_u32 v27, 4294901760, v27
  ds_read_b64_tr_b16 v[96:97], v27 offset:0
  ds_read_b64_tr_b16 v[98:99], v27 offset:384
  v_add_u32 v9, 0x20000, v7
  v_and_b32 v15, 31, v1
  s_waitcnt lgkmcnt(8)
  v_mfma_f32_32x32x16_bf16 v[64:79], v[112:115], v[152:155], v[64:79]
  ds_read_b64_tr_b16 v[100:101], v27 offset:32
  ds_read_b64_tr_b16 v[102:103], v27 offset:416
  v_lshrrev_b32 v16, 4, v15
  v_lshlrev_b32 v16, 12, v16
  s_waitcnt lgkmcnt(8)
  v_mfma_f32_32x32x16_bf16 v[32:47], v[116:119], v[156:159], v[32:47]
  ds_read_b64_tr_b16 v[104:105], v27 offset:64
  ds_read_b64_tr_b16 v[106:107], v27 offset:448
  s_lshl_b32 s70, s74, 13
  v_add_u32 v16, s70, v16
  s_waitcnt lgkmcnt(8)
  v_mfma_f32_32x32x16_bf16 v[48:63], v[120:123], v[156:159], v[48:63]
  ds_read_b64_tr_b16 v[108:109], v27 offset:1536
  ds_read_b64_tr_b16 v[110:111], v27 offset:1920
  v_and_b32 v17, 15, v1
  v_lshlrev_b32 v17, 7, v17
  s_waitcnt lgkmcnt(8)
  v_mfma_f32_32x32x16_bf16 v[64:79], v[124:127], v[156:159], v[64:79]
  ds_read_b64_tr_b16 v[112:113], v27 offset:1568
  ds_read_b64_tr_b16 v[114:115], v27 offset:1952
  v_add_u32 v16, v16, v17
  v_bfe_u32 v17, v1, 1, 3
  s_waitcnt lgkmcnt(8)
  v_mfma_f32_32x32x16_bf16 v[32:47], v[96:99], v[160:163], v[32:47]
  ds_read_b64_tr_b16 v[116:117], v27 offset:1600
  ds_read_b64_tr_b16 v[118:119], v27 offset:1984
  v_mov_b32 v19, 11
  ds_write_b32 v31, v19
  v_xor_b32 v17, v17, v14
  v_lshlrev_b32 v17, 4, v17
  s_waitcnt lgkmcnt(9)
  v_mfma_f32_32x32x16_bf16 v[48:63], v[100:103], v[160:163], v[48:63]
  ds_read_b64_tr_b16 v[120:121], v27 offset:3072
  ds_read_b64_tr_b16 v[122:123], v27 offset:3456
  v_add_u32 v80, v16, v17
  v_xor_b32 v81, 32, v80
  s_waitcnt lgkmcnt(9)
  v_mfma_f32_32x32x16_bf16 v[64:79], v[104:107], v[160:163], v[64:79]
  ds_read_b64_tr_b16 v[124:125], v27 offset:3104
  ds_read_b64_tr_b16 v[126:127], v27 offset:3488
  v_xor_b32 v82, 64, v80
  v_xor_b32 v83, 96, v80
  s_waitcnt lgkmcnt(9)
  v_mfma_f32_32x32x16_bf16 v[32:47], v[108:111], v[164:167], v[32:47]
  ds_read_b64_tr_b16 v[96:97], v27 offset:3136
  ds_read_b64_tr_b16 v[98:99], v27 offset:3520
  v_add_u32 v84, 0x10000, v80
  v_add_u32 v88, 0x20000, v80
  s_waitcnt lgkmcnt(9)
  v_mfma_f32_32x32x16_bf16 v[48:63], v[112:115], v[164:167], v[48:63]
  ds_read_b64_tr_b16 v[100:101], v27 offset:4608
  ds_read_b64_tr_b16 v[102:103], v27 offset:4992
  v_add_u32 v85, 0x10000, v81
  v_add_u32 v89, 0x20000, v81
  s_waitcnt lgkmcnt(9)
  v_mfma_f32_32x32x16_bf16 v[64:79], v[116:119], v[164:167], v[64:79]
  ds_read_b64_tr_b16 v[104:105], v27 offset:4640
  ds_read_b64_tr_b16 v[106:107], v27 offset:5024
  v_add_u32 v86, 0x10000, v82
  v_add_u32 v90, 0x20000, v82
  s_waitcnt lgkmcnt(8)
  v_mfma_f32_32x32x16_bf16 v[32:47], v[120:123], v[168:171], v[32:47]
  ds_read_b64_tr_b16 v[108:109], v27 offset:4672
  ds_read_b64_tr_b16 v[110:111], v27 offset:5056
  v_add_u32 v87, 0x10000, v83
  v_add_u32 v91, 0x20000, v83
  s_waitcnt lgkmcnt(8)
  v_mfma_f32_32x32x16_bf16 v[48:63], v[124:127], v[168:171], v[48:63]
  v_add_u32 v27, 16384, v27
  ds_read_b64_tr_b16 v[112:113], v27 offset:0
  ds_read_b64_tr_b16 v[114:115], v27 offset:384
  v_bfe_u32 v15, v1, 2, 1
  v_lshlrev_b32 v15, 4, v15
  s_waitcnt lgkmcnt(8)
  v_mfma_f32_32x32x16_bf16 v[64:79], v[96:99], v[168:171], v[64:79]
  ds_read_b64_tr_b16 v[116:117], v27 offset:32
  ds_read_b64_tr_b16 v[118:119], v27 offset:416
  v_bfe_u32 v16, v1, 3, 2
  v_lshlrev_b32 v16, 2, v16
  s_waitcnt lgkmcnt(8)
  v_mfma_f32_32x32x16_bf16 v[32:47], v[100:103], v[172:175], v[32:47]
  ds_read_b64_tr_b16 v[120:121], v27 offset:64
  ds_read_b64_tr_b16 v[122:123], v27 offset:448
  v_add_u32 v15, v15, v16
  v_and_b32 v16, 3, v1
  s_waitcnt lgkmcnt(8)
  v_mfma_f32_32x32x16_bf16 v[48:63], v[104:107], v[172:175], v[48:63]
  ds_read_b64_tr_b16 v[124:125], v27 offset:1536
  ds_read_b64_tr_b16 v[126:127], v27 offset:1920
  v_add_u32 v15, v15, v16
  s_lshl_b32 s69, s67, 6
  s_waitcnt lgkmcnt(8)
  v_mfma_f32_32x32x16_bf16 v[64:79], v[108:111], v[172:175], v[64:79]
  ds_read_b64_tr_b16 v[96:97], v27 offset:1568
  ds_read_b64_tr_b16 v[98:99], v27 offset:1952
  s_lshl_b32 s70, s73, 5
  s_add_u32 s69, s69, s70
  s_waitcnt lgkmcnt(8)
  v_mfma_f32_32x32x16_bf16 v[32:47], v[112:115], v[176:179], v[32:47]
  ds_read_b64_tr_b16 v[100:101], v27 offset:1600
  ds_read_b64_tr_b16 v[102:103], v27 offset:1984
  v_mov_b32 v19, 12
  ds_write_b32 v31, v19
  s_waitcnt vmcnt(0)
  v_mov_b32 v18, s66
  v_mov_b32 v19, 64
  s_mov_b64 exec, 1
  buffer_store_dword v18, v19, s[8:11], s91 offen sc1
  s_mov_b64 exec, -1
  v_add_u32 v15, s69, v15
  s_lshl_b32 s69, s68, 6
  s_waitcnt lgkmcnt(9)
  v_mfma_f32_32x32x16_bf16 v[48:63], v[116:119], v[176:179], v[48:63]
  ds_read_b64_tr_b16 v[104:105], v27 offset:3072
  ds_read_b64_tr_b16 v[106:107], v27 offset:3456
  s_lshl_b32 s70, s74, 5
  s_add_u32 s69, s69, s70
  s_waitcnt lgkmcnt(9)
  v_mfma_f32_32x32x16_bf16 v[64:79], v[120:123], v[176:179], v[64:79]
  ds_read_b64_tr_b16 v[108:109], v27 offset:3104
  ds_read_b64_tr_b16 v[110:111], v27 offset:3488
  v_lshlrev_b32 v16, 2, v14
  v_add_u32 v16, s69, v16
  s_waitcnt lgkmcnt(9)
  v_mfma_f32_32x32x16_bf16 v[32:47], v[124:127], v[180:183], v[32:47]
  ds_read_b64_tr_b16 v[112:113], v27 offset:3136
  ds_read_b64_tr_b16 v[114:115], v27 offset:3520
  v_lshlrev_b32 v11, 1, v16
  v_lshlrev_b32 v17, 10, v15
  s_waitcnt lgkmcnt(9)
  v_mfma_f32_32x32x16_bf16 v[48:63], v[96:99], v[180:183], v[48:63]
  ds_read_b64_tr_b16 v[116:117], v27 offset:4608
  ds_read_b64_tr_b16 v[118:119], v27 offset:4992
  v_add_u32 v95, v17, v11
  v_lshlrev_b32 v17, 11, v15
  s_waitcnt lgkmcnt(9)
  v_mfma_f32_32x32x16_bf16 v[64:79], v[100:103], v[180:183], v[64:79]
  ds_read_b64_tr_b16 v[120:121], v27 offset:4640
  ds_read_b64_tr_b16 v[122:123], v27 offset:5024
  v_lshlrev_b32 v20, 2, v16
  v_add_u32 v10, v17, v20
  s_waitcnt lgkmcnt(8)
  v_mfma_f32_32x32x16_bf16 v[32:47], v[104:107], v[184:187], v[32:47]
  ds_read_b64_tr_b16 v[124:125], v27 offset:4672
  ds_read_b64_tr_b16 v[126:127], v27 offset:5056
  v_lshlrev_b32 v12, 3, v15
  s_mov_b32 s24, s58
  s_waitcnt lgkmcnt(8)
  v_mfma_f32_32x32x16_bf16 v[48:63], v[108:111], v[184:187], v[48:63]
  v_add_u32 v27, 4294901760, v27
  ds_read_b64_tr_b16 v[96:97], v27 offset:0
  ds_read_b64_tr_b16 v[98:99], v27 offset:384
  s_mov_b32 s25, s59
  s_mov_b32 s26, 0x400000
  s_waitcnt lgkmcnt(8)
  v_mfma_f32_32x32x16_bf16 v[64:79], v[112:115], v[184:187], v[64:79]
  ds_read_b64_tr_b16 v[100:101], v27 offset:32
  ds_read_b64_tr_b16 v[102:103], v27 offset:416
  s_mov_b32 s20, s48
  s_mov_b32 s21, s49
  s_waitcnt lgkmcnt(8)
  v_mfma_f32_32x32x16_bf16 v[32:47], v[116:119], v[188:191], v[32:47]
  ds_read_b64_tr_b16 v[104:105], v27 offset:64
  ds_read_b64_tr_b16 v[106:107], v27 offset:448
  s_mov_b32 s22, 1024
  s_lshl_b32 s69, s67, 1
  s_waitcnt lgkmcnt(8)
  v_mfma_f32_32x32x16_bf16 v[48:63], v[120:123], v[188:191], v[48:63]
  ds_read_b64_tr_b16 v[108:109], v27 offset:1536
  ds_read_b64_tr_b16 v[110:111], v27 offset:1920
  s_add_u32 s69, s69, s73
  s_lshl_b32 s75, s69, 8
  s_waitcnt lgkmcnt(8)
  v_mfma_f32_32x32x16_bf16 v[64:79], v[124:127], v[188:191], v[64:79]
  ds_read_b64_tr_b16 v[112:113], v27 offset:1568
  ds_read_b64_tr_b16 v[114:115], v27 offset:1952
  s_add_u32 s75, s75, 32768
  s_lshl_b32 s70, s74, 11
  s_waitcnt lgkmcnt(8)
  v_mfma_f32_32x32x16_bf16 v[32:47], v[96:99], v[192:195], v[32:47]
  ds_read_b64_tr_b16 v[116:117], v27 offset:1600
  ds_read_b64_tr_b16 v[118:119], v27 offset:1984
  v_mov_b32 v19, 13
  ds_write_b32 v31, v19
  s_mul_i32 s76, s69, 114688
  s_add_u32 s76, s76, s70
  s_waitcnt lgkmcnt(9)
  v_mfma_f32_32x32x16_bf16 v[48:63], v[100:103], v[192:195], v[48:63]
  ds_read_b64_tr_b16 v[120:121], v27 offset:3072
  ds_read_b64_tr_b16 v[122:123], v27 offset:3456
  s_add_u32 s76, s76, 1048576
  s_lshl_b32 s77, s69, 16
  s_waitcnt lgkmcnt(9)
  v_mfma_f32_32x32x16_bf16 v[64:79], v[104:107], v[192:195], v[64:79]
  ds_read_b64_tr_b16 v[124:125], v27 offset:3104
  ds_read_b64_tr_b16 v[126:127], v27 offset:3488
  s_add_u32 s77, s77, s70
  s_add_u32 s77, s77, 8388608
  s_waitcnt lgkmcnt(9)
  v_mfma_f32_32x32x16_bf16 v[32:47], v[108:111], v[196:199], v[32:47]
  ds_read_b64_tr_b16 v[96:97], v27 offset:3136
  ds_read_b64_tr_b16 v[98:99], v27 offset:3520
  v_lshlrev_b32 v23, 2, v1
  v_lshrrev_b32 v24, 4, v1
  s_waitcnt lgkmcnt(9)
  v_mfma_f32_32x32x16_bf16 v[48:63], v[112:115], v[196:199], v[48:63]
  ds_read_b64_tr_b16 v[100:101], v27 offset:4608
  ds_read_b64_tr_b16 v[102:103], v27 offset:4992
  v_lshlrev_b32 v24, 12, v24
  v_and_b32 v25, 15, v1
  s_waitcnt lgkmcnt(9)
  v_mfma_f32_32x32x16_bf16 v[64:79], v[116:119], v[196:199], v[64:79]
  ds_read_b64_tr_b16 v[104:105], v27 offset:4640
  ds_read_b64_tr_b16 v[106:107], v27 offset:5024
  v_lshl_add_u32 v24, v25, 7, v24
  s_mov_b32 s92, 0x0000ffff
  s_waitcnt lgkmcnt(8)
  v_mfma_f32_32x32x16_bf16 v[32:47], v[120:123], v[200:203], v[32:47]
  ds_read_b64_tr_b16 v[108:109], v27 offset:4672
  ds_read_b64_tr_b16 v[110:111], v27 offset:5056
  s_mov_b32 s93, 0
  s_mov_b32 s94, 0xffff0000
  s_waitcnt lgkmcnt(8)
  v_mfma_f32_32x32x16_bf16 v[48:63], v[124:127], v[200:203], v[48:63]
  v_add_u32 v27, 81920, v27
  ds_read_b64_tr_b16 v[112:113], v27 offset:0
  ds_read_b64_tr_b16 v[114:115], v27 offset:384
  s_mov_b32 s95, 0
  s_mov_b32 s96, 0
  s_waitcnt lgkmcnt(8)
  v_mfma_f32_32x32x16_bf16 v[64:79], v[96:99], v[200:203], v[64:79]
  ds_read_b64_tr_b16 v[116:117], v27 offset:32
  ds_read_b64_tr_b16 v[118:119], v27 offset:416
  s_mov_b32 s97, 0x0000ffff
  s_waitcnt lgkmcnt(8)
  v_mfma_f32_32x32x16_bf16 v[32:47], v[100:103], v[204:207], v[32:47]
  ds_read_b64_tr_b16 v[120:121], v27 offset:64
  ds_read_b64_tr_b16 v[122:123], v27 offset:448
  s_waitcnt lgkmcnt(8)
  v_mfma_f32_32x32x16_bf16 v[48:63], v[104:107], v[204:207], v[48:63]
  ds_read_b64_tr_b16 v[124:125], v27 offset:1536
  ds_read_b64_tr_b16 v[126:127], v27 offset:1920
  s_waitcnt lgkmcnt(8)
  v_mfma_f32_32x32x16_bf16 v[64:79], v[108:111], v[204:207], v[64:79]
  ds_read_b64_tr_b16 v[96:97], v27 offset:1568
  ds_read_b64_tr_b16 v[98:99], v27 offset:1952
  s_waitcnt lgkmcnt(8)
  v_mfma_f32_32x32x16_bf16 v[32:47], v[112:115], v[208:211], v[32:47]
  ds_read_b64_tr_b16 v[100:101], v27 offset:1600
  ds_read_b64_tr_b16 v[102:103], v27 offset:1984
  v_mov_b32 v19, 14
  ds_write_b32 v31, v19
  s_waitcnt lgkmcnt(9)
  v_mfma_f32_32x32x16_bf16 v[48:63], v[116:119], v[208:211], v[48:63]
  ds_read_b64_tr_b16 v[104:105], v27 offset:3072
  ds_read_b64_tr_b16 v[106:107], v27 offset:3456
  s_waitcnt lgkmcnt(9)
  v_mfma_f32_32x32x16_bf16 v[64:79], v[120:123], v[208:211], v[64:79]
  ds_read_b64_tr_b16 v[108:109], v27 offset:3104
  ds_read_b64_tr_b16 v[110:111], v27 offset:3488
  s_waitcnt lgkmcnt(9)
  v_mfma_f32_32x32x16_bf16 v[32:47], v[124:127], v[212:215], v[32:47]
  ds_read_b64_tr_b16 v[112:113], v27 offset:3136
  ds_read_b64_tr_b16 v[114:115], v27 offset:3520
  s_waitcnt lgkmcnt(9)
  v_mfma_f32_32x32x16_bf16 v[48:63], v[96:99], v[212:215], v[48:63]
  ds_read_b64_tr_b16 v[116:117], v27 offset:4608
  ds_read_b64_tr_b16 v[118:119], v27 offset:4992
  s_waitcnt lgkmcnt(9)
  v_mfma_f32_32x32x16_bf16 v[64:79], v[100:103], v[212:215], v[64:79]
  ds_read_b64_tr_b16 v[120:121], v27 offset:4640
  ds_read_b64_tr_b16 v[122:123], v27 offset:5024
  s_waitcnt lgkmcnt(8)
  v_mfma_f32_32x32x16_bf16 v[32:47], v[104:107], v[216:219], v[32:47]
  ds_read_b64_tr_b16 v[124:125], v27 offset:4672
  ds_read_b64_tr_b16 v[126:127], v27 offset:5056
  s_waitcnt lgkmcnt(8)
  v_mfma_f32_32x32x16_bf16 v[48:63], v[108:111], v[216:219], v[48:63]
  v_add_u32 v27, 4294901760, v27
  ds_read_b64_tr_b16 v[96:97], v27 offset:0
  ds_read_b64_tr_b16 v[98:99], v27 offset:384
  s_waitcnt lgkmcnt(8)
  v_mfma_f32_32x32x16_bf16 v[64:79], v[112:115], v[216:219], v[64:79]
  ds_read_b64_tr_b16 v[100:101], v27 offset:32
  ds_read_b64_tr_b16 v[102:103], v27 offset:416
  s_waitcnt lgkmcnt(8)
  v_mfma_f32_32x32x16_bf16 v[32:47], v[116:119], v[220:223], v[32:47]
  ds_read_b64_tr_b16 v[104:105], v27 offset:64
  ds_read_b64_tr_b16 v[106:107], v27 offset:448
  s_waitcnt lgkmcnt(8)
  v_mfma_f32_32x32x16_bf16 v[48:63], v[120:123], v[220:223], v[48:63]
  ds_read_b64_tr_b16 v[108:109], v27 offset:1536
  ds_read_b64_tr_b16 v[110:111], v27 offset:1920
  s_waitcnt lgkmcnt(8)
  v_mfma_f32_32x32x16_bf16 v[64:79], v[124:127], v[220:223], v[64:79]
  ds_read_b64_tr_b16 v[112:113], v27 offset:1568
  ds_read_b64_tr_b16 v[114:115], v27 offset:1952
  s_waitcnt lgkmcnt(8)
  v_mfma_f32_32x32x16_bf16 v[32:47], v[96:99], v[224:227], v[32:47]
  ds_read_b64_tr_b16 v[116:117], v27 offset:1600
  ds_read_b64_tr_b16 v[118:119], v27 offset:1984
  v_mov_b32 v19, 15
  ds_write_b32 v31, v19
  s_waitcnt lgkmcnt(9)
  v_mfma_f32_32x32x16_bf16 v[48:63], v[100:103], v[224:227], v[48:63]
  ds_read_b64_tr_b16 v[120:121], v27 offset:3072
  ds_read_b64_tr_b16 v[122:123], v27 offset:3456
  s_waitcnt lgkmcnt(9)
  v_mfma_f32_32x32x16_bf16 v[64:79], v[104:107], v[224:227], v[64:79]
  ds_read_b64_tr_b16 v[124:125], v27 offset:3104
  ds_read_b64_tr_b16 v[126:127], v27 offset:3488
  ds_read_b32 v18, v2 offset:1024
  s_waitcnt lgkmcnt(10)
  v_mfma_f32_32x32x16_bf16 v[32:47], v[108:111], v[228:231], v[32:47]
  ds_read_b64_tr_b16 v[96:97], v27 offset:3136
  ds_read_b64_tr_b16 v[98:99], v27 offset:3520
  s_waitcnt lgkmcnt(10)
  v_mfma_f32_32x32x16_bf16 v[48:63], v[112:115], v[228:231], v[48:63]
  ds_read_b64_tr_b16 v[100:101], v27 offset:4608
  ds_read_b64_tr_b16 v[102:103], v27 offset:4992
  s_waitcnt lgkmcnt(10)
  v_mfma_f32_32x32x16_bf16 v[64:79], v[116:119], v[228:231], v[64:79]
  ds_read_b64_tr_b16 v[104:105], v27 offset:4640
  ds_read_b64_tr_b16 v[106:107], v27 offset:5024
  s_waitcnt lgkmcnt(9)
  v_mfma_f32_32x32x16_bf16 v[32:47], v[120:123], v[232:235], v[32:47]
  ds_read_b64_tr_b16 v[108:109], v27 offset:4672
  ds_read_b64_tr_b16 v[110:111], v27 offset:5056
  s_waitcnt lgkmcnt(9)
  v_mfma_f32_32x32x16_bf16 v[48:63], v[124:127], v[232:235], v[48:63]
  s_waitcnt lgkmcnt(8)
  v_cmp_gt_u32 vcc, 10, v18
  s_cbranch_vccnz L_br6_s
L_br6_k:
  v_add_u32 v27, 16384, v27
  ds_read_b64_tr_b16 v[112:113], v27 offset:0
  ds_read_b64_tr_b16 v[114:115], v27 offset:384
  s_waitcnt lgkmcnt(8)
  v_mfma_f32_32x32x16_bf16 v[64:79], v[96:99], v[232:235], v[64:79]
  ds_read_b64_tr_b16 v[116:117], v27 offset:32
  ds_read_b64_tr_b16 v[118:119], v27 offset:416
  s_waitcnt lgkmcnt(8)
  v_mfma_f32_32x32x16_bf16 v[32:47], v[100:103], v[236:239], v[32:47]
  ds_read_b64_tr_b16 v[120:121], v27 offset:64
  ds_read_b64_tr_b16 v[122:123], v27 offset:448
  s_waitcnt lgkmcnt(8)
  v_mfma_f32_32x32x16_bf16 v[48:63], v[104:107], v[236:239], v[48:63]
  ds_read_b64_tr_b16 v[124:125], v27 offset:1536
  ds_read_b64_tr_b16 v[126:127], v27 offset:1920
  s_waitcnt lgkmcnt(8)
  v_mfma_f32_32x32x16_bf16 v[64:79], v[108:111], v[236:239], v[64:79]
  ds_read_b64_tr_b16 v[96:97], v27 offset:1568
  ds_read_b64_tr_b16 v[98:99], v27 offset:1952
  s_waitcnt lgkmcnt(8)
  v_mfma_f32_32x32x16_bf16 v[32:47], v[112:115], v[240:243], v[32:47]
  ds_read_b64_tr_b16 v[100:101], v27 offset:1600
  ds_read_b64_tr_b16 v[102:103], v27 offset:1984
  v_mov_b32 v19, 16
  ds_write_b32 v31, v19
  s_waitcnt lgkmcnt(9)
  v_mfma_f32_32x32x16_bf16 v[48:63], v[116:119], v[240:243], v[48:63]
  ds_read_b64_tr_b16 v[104:105], v27 offset:3072
  ds_read_b64_tr_b16 v[106:107], v27 offset:3456
  s_waitcnt lgkmcnt(9)
  v_mfma_f32_32x32x16_bf16 v[64:79], v[120:123], v[240:243], v[64:79]
  ds_read_b64_tr_b16 v[108:109], v27 offset:3104
  ds_read_b64_tr_b16 v[110:111], v27 offset:3488
  s_waitcnt lgkmcnt(9)
  v_mfma_f32_32x32x16_bf16 v[32:47], v[124:127], v[244:247], v[32:47]
  ds_read_b64_tr_b16 v[112:113], v27 offset:3136
  ds_read_b64_tr_b16 v[114:115], v27 offset:3520
  s_waitcnt lgkmcnt(9)
  v_mfma_f32_32x32x16_bf16 v[48:63], v[96:99], v[244:247], v[48:63]
  ds_read_b64_tr_b16 v[116:117], v27 offset:4608
  ds_read_b64_tr_b16 v[118:119], v27 offset:4992
  s_waitcnt lgkmcnt(9)
  v_mfma_f32_32x32x16_bf16 v[64:79], v[100:103], v[244:247], v[64:79]
  ds_read_b64_tr_b16 v[120:121], v27 offset:4640
  ds_read_b64_tr_b16 v[122:123], v27 offset:5024
  s_waitcnt lgkmcnt(8)
  v_mfma_f32_32x32x16_bf16 v[32:47], v[104:107], v[248:251], v[32:47]
  ds_read_b64_tr_b16 v[124:125], v27 offset:4672
  ds_read_b64_tr_b16 v[126:127], v27 offset:5056
  s_waitcnt lgkmcnt(8)
  v_mfma_f32_32x32x16_bf16 v[48:63], v[108:111], v[248:251], v[48:63]
  s_waitcnt lgkmcnt(6)
  v_mfma_f32_32x32x16_bf16 v[64:79], v[112:115], v[248:251], v[64:79]
  s_waitcnt lgkmcnt(4)
  v_mfma_f32_32x32x16_bf16 v[32:47], v[116:119], v[252:255], v[32:47]
  s_waitcnt lgkmcnt(2)
  v_mfma_f32_32x32x16_bf16 v[48:63], v[120:123], v[252:255], v[48:63]
  s_waitcnt lgkmcnt(0)
  v_mfma_f32_32x32x16_bf16 v[64:79], v[124:127], v[252:255], v[64:79]
  v_mov_b32 v19, 17
  ds_write_b32 v31, v19
  v_and_b32 v18, 31, v1
  v_lshlrev_b32 v18, 3, v18
  v_add_u32 v18, 154624, v18
  ds_read_b64 v[96:97], v18 offset:1024
  ds_read_b64 v[100:101], v18 offset:1280
  ds_read_b64 v[104:105], v18 offset:1536
  v_mov_b32 v98, 0
  v_mov_b32 v99, 0
  v_mov_b32 v102, 0
  v_mov_b32 v103, 0
  v_mov_b32 v106, 0
  v_mov_b32 v107, 0
  v_mov_b32 v112, v30
  v_lshrrev_b32 v113, 16, v30
  v_mov_b32 v114, 0
  v_mov_b32 v115, 0
  s_waitcnt lgkmcnt(0)
  s_nop 0
  v_mfma_f32_32x32x16_bf16 v[32:47], v[96:99], v[112:115], v[32:47]
  v_mfma_f32_32x32x16_bf16 v[48:63], v[100:103], v[112:115], v[48:63]
  v_mfma_f32_32x32x16_bf16 v[64:79], v[104:107], v[112:115], v[64:79]
  s_nop 9
  v_mul_f32 v18, v32, v29
  v_mul_f32 v19, v33, v29
  v_exp_f32 v18, v18
  v_exp_f32 v19, v19
  v_mul_f32 v32, v32, v40
  v_mul_f32 v33, v33, v41
  v_add_f32 v18, 1.0, v18
  v_add_f32 v19, 1.0, v19
  v_rcp_f32 v18, v18
  v_rcp_f32 v19, v19
  v_mul_f32 v32, v32, v18
  v_mul_f32 v33, v33, v19
  v_cvt_pk_bf16_f32 v40, v32, v33
  v_mul_f32 v18, v34, v29
  v_mul_f32 v19, v35, v29
  v_exp_f32 v18, v18
  v_exp_f32 v19, v19
  v_mul_f32 v34, v34, v42
  v_mul_f32 v35, v35, v43
  v_add_f32 v18, 1.0, v18
  v_add_f32 v19, 1.0, v19
  v_rcp_f32 v18, v18
  v_rcp_f32 v19, v19
  v_mul_f32 v34, v34, v18
  v_mul_f32 v35, v35, v19
  v_cvt_pk_bf16_f32 v41, v34, v35
  v_mul_f32 v18, v36, v29
  v_mul_f32 v19, v37, v29
  v_exp_f32 v18, v18
  v_exp_f32 v19, v19
  v_mul_f32 v36, v36, v44
  v_mul_f32 v37, v37, v45
  v_add_f32 v18, 1.0, v18
  v_add_f32 v19, 1.0, v19
  v_rcp_f32 v18, v18
  v_rcp_f32 v19, v19
  v_mul_f32 v36, v36, v18
  v_mul_f32 v37, v37, v19
  v_cvt_pk_bf16_f32 v42, v36, v37
  v_mul_f32 v18, v38, v29
  v_mul_f32 v19, v39, v29
  v_exp_f32 v18, v18
  v_exp_f32 v19, v19
  v_mul_f32 v38, v38, v46
  v_mul_f32 v39, v39, v47
  v_add_f32 v18, 1.0, v18
  v_add_f32 v19, 1.0, v19
  v_rcp_f32 v18, v18
  v_rcp_f32 v19, v19
  v_mul_f32 v38, v38, v18
  v_mul_f32 v39, v39, v19
  v_cvt_pk_bf16_f32 v43, v38, v39
  buffer_store_dwordx4 v[40:43], v28, s[8:11], s89 offen offset:0 sc1
  v_mul_f32 v18, v48, v29
  v_mul_f32 v19, v49, v29
  v_exp_f32 v18, v18
  v_exp_f32 v19, v19
  v_mul_f32 v48, v48, v56
  v_mul_f32 v49, v49, v57
  v_add_f32 v18, 1.0, v18
  v_add_f32 v19, 1.0, v19
  v_rcp_f32 v18, v18
  v_rcp_f32 v19, v19
  v_mul_f32 v48, v48, v18
  v_mul_f32 v49, v49, v19
  v_cvt_pk_bf16_f32 v56, v48, v49
  v_mul_f32 v18, v50, v29
  v_mul_f32 v19, v51, v29
  v_exp_f32 v18, v18
  v_exp_f32 v19, v19
  v_mul_f32 v50, v50, v58
  v_mul_f32 v51, v51, v59
  v_add_f32 v18, 1.0, v18
  v_add_f32 v19, 1.0, v19
  v_rcp_f32 v18, v18
  v_rcp_f32 v19, v19
  v_mul_f32 v50, v50, v18
  v_mul_f32 v51, v51, v19
  v_cvt_pk_bf16_f32 v57, v50, v51
  v_mul_f32 v18, v52, v29
  v_mul_f32 v19, v53, v29
  v_exp_f32 v18, v18
  v_exp_f32 v19, v19
  v_mul_f32 v52, v52, v60
  v_mul_f32 v53, v53, v61
  v_add_f32 v18, 1.0, v18
  v_add_f32 v19, 1.0, v19
  v_rcp_f32 v18, v18
  v_rcp_f32 v19, v19
  v_mul_f32 v52, v52, v18
  v_mul_f32 v53, v53, v19
  v_cvt_pk_bf16_f32 v58, v52, v53
  v_mul_f32 v18, v54, v29
  v_mul_f32 v19, v55, v29
  v_exp_f32 v18, v18
  v_exp_f32 v19, v19
  v_mul_f32 v54, v54, v62
  v_mul_f32 v55, v55, v63
  v_add_f32 v18, 1.0, v18
  v_add_f32 v19, 1.0, v19
  v_rcp_f32 v18, v18
  v_rcp_f32 v19, v19
  v_mul_f32 v54, v54, v18
  v_mul_f32 v55, v55, v19
  v_cvt_pk_bf16_f32 v59, v54, v55
  buffer_store_dwordx4 v[56:59], v28, s[8:11], s89 offen offset:1024 sc1
  v_mul_f32 v18, v64, v29
  v_mul_f32 v19, v65, v29
  v_exp_f32 v18, v18
  v_exp_f32 v19, v19
  v_mul_f32 v64, v64, v72
  v_mul_f32 v65, v65, v73
  v_add_f32 v18, 1.0, v18
  v_add_f32 v19, 1.0, v19
  v_rcp_f32 v18, v18
  v_rcp_f32 v19, v19
  v_mul_f32 v64, v64, v18
  v_mul_f32 v65, v65, v19
  v_cvt_pk_bf16_f32 v72, v64, v65
  v_mul_f32 v18, v66, v29
  v_mul_f32 v19, v67, v29
  v_exp_f32 v18, v18
  v_exp_f32 v19, v19
  v_mul_f32 v66, v66, v74
  v_mul_f32 v67, v67, v75
  v_add_f32 v18, 1.0, v18
  v_add_f32 v19, 1.0, v19
  v_rcp_f32 v18, v18
  v_rcp_f32 v19, v19
  v_mul_f32 v66, v66, v18
  v_mul_f32 v67, v67, v19
  v_cvt_pk_bf16_f32 v73, v66, v67
  v_mul_f32 v18, v68, v29
  v_mul_f32 v19, v69, v29
  v_exp_f32 v18, v18
  v_exp_f32 v19, v19
  v_mul_f32 v68, v68, v76
  v_mul_f32 v69, v69, v77
  v_add_f32 v18, 1.0, v18
  v_add_f32 v19, 1.0, v19
  v_rcp_f32 v18, v18
  v_rcp_f32 v19, v19
  v_mul_f32 v68, v68, v18
  v_mul_f32 v69, v69, v19
  v_cvt_pk_bf16_f32 v74, v68, v69
  v_mul_f32 v18, v70, v29
  v_mul_f32 v19, v71, v29
  v_exp_f32 v18, v18
  v_exp_f32 v19, v19
  v_mul_f32 v70, v70, v78
  v_mul_f32 v71, v71, v79
  v_add_f32 v18, 1.0, v18
  v_add_f32 v19, 1.0, v19
  v_rcp_f32 v18, v18
  v_rcp_f32 v19, v19
  v_mul_f32 v70, v70, v18
  v_mul_f32 v71, v71, v19
  v_cvt_pk_bf16_f32 v75, v70, v71
  buffer_store_dwordx4 v[72:75], v28, s[8:11], s89 offen offset:2048 sc1
  buffer_load_dwordx2 v[226:227], v95, s[4:7], 0 offen offset:0
  buffer_load_dwordx2 v[228:229], v95, s[4:7], 0 offen offset:16
  buffer_load_dwordx2 v[230:231], v95, s[4:7], 0 offen offset:32
  buffer_load_dwordx2 v[232:233], v95, s[4:7], 0 offen offset:48
  buffer_load_dwordx2 v[234:235], v11, s[20:23], 0 offen offset:0
  buffer_load_dwordx2 v[236:237], v11, s[20:23], 0 offen offset:16
  buffer_load_dwordx2 v[238:239], v11, s[20:23], 0 offen offset:32
  buffer_load_dwordx2 v[240:241], v11, s[20:23], 0 offen offset:48
  s_barrier
  ds_read_b128 v[160:163], v84 offset:32768
  ds_read_b64_tr_b16 v[176:177], v8 offset:32768
  ds_read_b64_tr_b16 v[178:179], v8 offset:33024
  ds_read_b128 v[164:167], v85 offset:32768
  ds_read_b64_tr_b16 v[180:181], v8 offset:33792
  ds_read_b64_tr_b16 v[182:183], v8 offset:34048
  ds_read_b128 v[168:171], v86 offset:32768
  ds_read_b64_tr_b16 v[184:185], v8 offset:36864
  ds_read_b64_tr_b16 v[186:187], v8 offset:37120
  ds_read_b128 v[172:175], v87 offset:32768
  ds_read_b64_tr_b16 v[188:189], v8 offset:37888
  ds_read_b64_tr_b16 v[190:191], v8 offset:38144
  s_barrier
  s_waitcnt lgkmcnt(9)
  v_mfma_f32_32x32x16_bf16 v[144:159], v[160:163], v[176:179], 0
  ds_read_b128 v[192:195], v88 offset:0
  ds_read_b64_tr_b16 v[208:209], v9 offset:0
  ds_read_b64_tr_b16 v[210:211], v9 offset:256
  s_waitcnt lgkmcnt(9)
  v_mfma_f32_32x32x16_bf16 v[144:159], v[164:167], v[180:183], v[144:159]
  ds_read_b128 v[196:199], v89 offset:0
  ds_read_b64_tr_b16 v[212:213], v9 offset:1024
  ds_read_b64_tr_b16 v[214:215], v9 offset:1280
  s_waitcnt lgkmcnt(9)
  v_mfma_f32_32x32x16_bf16 v[144:159], v[168:171], v[184:187], v[144:159]
  ds_read_b128 v[200:203], v90 offset:0
  ds_read_b64_tr_b16 v[216:217], v9 offset:4096
  ds_read_b64_tr_b16 v[218:219], v9 offset:4352
  buffer_load_dword v25, v23, s[8:11], s75 offen sc1
  s_waitcnt lgkmcnt(9)
  v_mfma_f32_32x32x16_bf16 v[144:159], v[172:175], v[188:191], v[144:159]
  ds_read_b128 v[204:207], v91 offset:0
  ds_read_b64_tr_b16 v[220:221], v9 offset:5120
  ds_read_b64_tr_b16 v[222:223], v9 offset:5376
  s_barrier
  s_waitcnt lgkmcnt(9)
  v_mfma_f32_32x32x16_bf16 v[144:159], v[192:195], v[208:211], v[144:159]
  ds_read_b128 v[160:163], v84 offset:49152
  ds_read_b64_tr_b16 v[176:177], v8 offset:49152
  ds_read_b64_tr_b16 v[178:179], v8 offset:49408
  s_waitcnt lgkmcnt(9)
  v_mfma_f32_32x32x16_bf16 v[144:159], v[196:199], v[212:215], v[144:159]
  ds_read_b128 v[164:167], v85 offset:49152
  ds_read_b64_tr_b16 v[180:181], v8 offset:50176
  ds_read_b64_tr_b16 v[182:183], v8 offset:50432
  s_waitcnt lgkmcnt(9)
  v_mfma_f32_32x32x16_bf16 v[144:159], v[200:203], v[216:219], v[144:159]
  ds_read_b128 v[168:171], v86 offset:49152
  ds_read_b64_tr_b16 v[184:185], v8 offset:53248
  ds_read_b64_tr_b16 v[186:187], v8 offset:53504
  s_waitcnt lgkmcnt(9)
  v_mfma_f32_32x32x16_bf16 v[144:159], v[204:207], v[220:223], v[144:159]
  ds_read_b128 v[172:175], v87 offset:49152
  ds_read_b64_tr_b16 v[188:189], v8 offset:54272
  ds_read_b64_tr_b16 v[190:191], v8 offset:54528
  s_barrier
  s_waitcnt lgkmcnt(9)
  v_mfma_f32_32x32x16_bf16 v[144:159], v[160:163], v[176:179], v[144:159]
  ds_read_b128 v[192:195], v80 offset:49152
  ds_read_b64_tr_b16 v[208:209], v7 offset:49152
  ds_read_b64_tr_b16 v[210:211], v7 offset:49408
  v_and_b32 v106, 31, v1
  v_lshlrev_b32 v100, 7, v106
  v_lshrrev_b32 v107, 5, v1
  v_and_b32 v106, 7, v1
  v_xor_b32 v107, v107, v106
  s_waitcnt lgkmcnt(9)
  v_mfma_f32_32x32x16_bf16 v[144:159], v[164:167], v[180:183], v[144:159]
  ds_read_b128 v[196:199], v81 offset:49152
  ds_read_b64_tr_b16 v[212:213], v7 offset:50176
  ds_read_b64_tr_b16 v[214:215], v7 offset:50432
  s_waitcnt lgkmcnt(9)
  v_mfma_f32_32x32x16_bf16 v[144:159], v[168:171], v[184:187], v[144:159]
  ds_read_b128 v[200:203], v82 offset:49152
  ds_read_b64_tr_b16 v[216:217], v7 offset:53248
  ds_read_b64_tr_b16 v[218:219], v7 offset:53504
  s_waitcnt vmcnt(0)
  v_cmp_ne_u32 vcc, s66, v25
  s_and_b64 vcc, vcc, s[94:95]
  s_cbranch_vccnz L_fb1_s
L_fb1_k:
  s_mov_b32 s72, 65536
  buffer_load_dwordx2 v[224:225], v12, s[8:11], s72 offen sc1
  s_waitcnt lgkmcnt(9)
  v_mfma_f32_32x32x16_bf16 v[144:159], v[172:175], v[188:191], v[144:159]
  ds_read_b128 v[204:207], v83 offset:49152
  ds_read_b64_tr_b16 v[220:221], v7 offset:54272
  ds_read_b64_tr_b16 v[222:223], v7 offset:54528
  s_barrier
  s_waitcnt lgkmcnt(9)
  v_mfma_f32_32x32x16_bf16 v[144:159], v[192:195], v[208:211], v[144:159]
  ds_read_b128 v[160:163], v84 offset:0
  ds_read_b64_tr_b16 v[176:177], v8 offset:0
  ds_read_b64_tr_b16 v[178:179], v8 offset:256
  v_lshlrev_b32 v107, 4, v107
  s_lshl_b32 s69, s62, 12
  s_add_u32 s69, s69, 0
  v_add3_u32 v100, v100, v107, s69
  v_xor_b32 v101, 32, v100
  s_waitcnt lgkmcnt(9)
  v_mfma_f32_32x32x16_bf16 v[144:159], v[196:199], v[212:215], v[144:159]
  ds_read_b128 v[164:167], v85 offset:0
  ds_read_b64_tr_b16 v[180:181], v8 offset:1024
  ds_read_b64_tr_b16 v[182:183], v8 offset:1280
  s_waitcnt lgkmcnt(9)
  v_mfma_f32_32x32x16_bf16 v[144:159], v[200:203], v[216:219], v[144:159]
  ds_read_b128 v[168:171], v86 offset:0
  ds_read_b64_tr_b16 v[184:185], v8 offset:4096
  ds_read_b64_tr_b16 v[186:187], v8 offset:4352
  v_mov_b32 v70, s66
  v_mov_b32 v71, 128
  s_mov_b64 exec, 1
  buffer_store_dword v70, v71, s[8:11], s91 offen sc1
  s_mov_b64 exec, -1
  s_waitcnt lgkmcnt(9)
  v_mfma_f32_32x32x16_bf16 v[144:159], v[204:207], v[220:223], v[144:159]
  ds_read_b128 v[172:175], v87 offset:0
  ds_read_b64_tr_b16 v[188:189], v8 offset:5120
  ds_read_b64_tr_b16 v[190:191], v8 offset:5376
  s_barrier
  s_waitcnt lgkmcnt(9)
  v_mfma_f32_32x32x16_bf16 v[144:159], v[160:163], v[176:179], v[144:159]
  ds_read_b128 v[192:195], v80 offset:0
  ds_read_b64_tr_b16 v[208:209], v7 offset:0
  ds_read_b64_tr_b16 v[210:211], v7 offset:256
  v_xor_b32 v102, 64, v100
  v_xor_b32 v103, 96, v100
  v_lshrrev_b32 v107, 3, v1
  v_xor_b32 v104, v107, v106
  v_lshlrev_b32 v104, 4, v104
  s_waitcnt lgkmcnt(9)
  v_mfma_f32_32x32x16_bf16 v[144:159], v[164:167], v[180:183], v[144:159]
  ds_read_b128 v[196:199], v81 offset:0
  ds_read_b64_tr_b16 v[212:213], v7 offset:1024
  ds_read_b64_tr_b16 v[214:215], v7 offset:1280
  s_waitcnt lgkmcnt(9)
  v_mfma_f32_32x32x16_bf16 v[144:159], v[168:171], v[184:187], v[144:159]
  ds_read_b128 v[200:203], v82 offset:0
  ds_read_b64_tr_b16 v[216:217], v7 offset:4096
  ds_read_b64_tr_b16 v[218:219], v7 offset:4352
  s_waitcnt lgkmcnt(9)
  v_mfma_f32_32x32x16_bf16 v[144:159], v[172:175], v[188:191], v[144:159]
  ds_read_b128 v[204:207], v83 offset:0
  ds_read_b64_tr_b16 v[220:221], v7 offset:5120
  ds_read_b64_tr_b16 v[222:223], v7 offset:5376
  s_barrier
  s_waitcnt lgkmcnt(9)
  v_mfma_f32_32x32x16_bf16 v[144:159], v[192:195], v[208:211], v[144:159]
  ds_read_b128 v[160:163], v84 offset:16384
  ds_read_b64_tr_b16 v[176:177], v8 offset:16384
  ds_read_b64_tr_b16 v[178:179], v8 offset:16640
  v_lshlrev_b32 v105, 7, v107
  s_lshl_b32 s69, s62, 12
  s_add_u32 s69, s69, 0
  v_add3_u32 v104, v104, v105, s69
  v_and_b32 v107, 3, v107
  s_waitcnt lgkmcnt(9)
  v_mfma_f32_32x32x16_bf16 v[144:159], v[196:199], v[212:215], v[144:159]
  ds_read_b128 v[164:167], v85 offset:16384
  ds_read_b64_tr_b16 v[180:181], v8 offset:17408
  ds_read_b64_tr_b16 v[182:183], v8 offset:17664
  s_waitcnt lgkmcnt(9)
  v_mfma_f32_32x32x16_bf16 v[144:159], v[200:203], v[216:219], v[144:159]
  ds_read_b128 v[168:171], v86 offset:16384
  ds_read_b64_tr_b16 v[184:185], v8 offset:20480
  ds_read_b64_tr_b16 v[186:187], v8 offset:20736
  s_waitcnt lgkmcnt(9)
  v_mfma_f32_32x32x16_bf16 v[144:159], v[204:207], v[220:223], v[144:159]
  ds_read_b128 v[172:175], v87 offset:16384
  ds_read_b64_tr_b16 v[188:189], v8 offset:21504
  ds_read_b64_tr_b16 v[190:191], v8 offset:21760
  s_barrier
  s_waitcnt lgkmcnt(9)
  v_mfma_f32_32x32x16_bf16 v[144:159], v[160:163], v[176:179], v[144:159]
  ds_read_b128 v[192:195], v80 offset:16384
  ds_read_b64_tr_b16 v[208:209], v7 offset:16384
  ds_read_b64_tr_b16 v[210:211], v7 offset:16640
  v_lshrrev_b32 v105, 5, v1
  v_lshl_add_u32 v107, v105, 4, v107
  v_lshlrev_b32 v107, 11, v107
  v_lshl_add_u32 v107, v106, 4, v107
  v_readfirstlane_b32 s69, v10
  s_waitcnt lgkmcnt(9)
  v_mfma_f32_32x32x16_bf16 v[144:159], v[164:167], v[180:183], v[144:159]
  ds_read_b128 v[196:199], v81 offset:16384
  ds_read_b64_tr_b16 v[212:213], v7 offset:17408
  ds_read_b64_tr_b16 v[214:215], v7 offset:17664
  s_waitcnt lgkmcnt(9)
  v_mfma_f32_32x32x16_bf16 v[144:159], v[168:171], v[184:187], v[144:159]
  ds_read_b128 v[200:203], v82 offset:16384
  ds_read_b64_tr_b16 v[216:217], v7 offset:20480
  ds_read_b64_tr_b16 v[218:219], v7 offset:20736
  s_waitcnt lgkmcnt(9)
  v_mfma_f32_32x32x16_bf16 v[144:159], v[172:175], v[188:191], v[144:159]
  ds_read_b128 v[204:207], v83 offset:16384
  ds_read_b64_tr_b16 v[220:221], v7 offset:21504
  ds_read_b64_tr_b16 v[222:223], v7 offset:21760
  s_barrier
  s_waitcnt lgkmcnt(9)
  v_mfma_f32_32x32x16_bf16 v[144:159], v[192:195], v[208:211], v[144:159]
  ds_read_b128 v[160:163], v80 offset:32768
  ds_read_b64_tr_b16 v[176:177], v7 offset:32768
  ds_read_b64_tr_b16 v[178:179], v7 offset:33024
  v_readfirstlane_b32 s69, v10
  s_nop 3
  v_add_u32 v105, s69, v107
  s_waitcnt lgkmcnt(9)
  v_mfma_f32_32x32x16_bf16 v[144:159], v[196:199], v[212:215], v[144:159]
  ds_read_b128 v[164:167], v81 offset:32768
  ds_read_b64_tr_b16 v[180:181], v7 offset:33792
  ds_read_b64_tr_b16 v[182:183], v7 offset:34048
  s_waitcnt lgkmcnt(9)
  v_mfma_f32_32x32x16_bf16 v[144:159], v[200:203], v[216:219], v[144:159]
  ds_read_b128 v[168:171], v82 offset:32768
  ds_read_b64_tr_b16 v[184:185], v7 offset:36864
  ds_read_b64_tr_b16 v[186:187], v7 offset:37120
  s_waitcnt lgkmcnt(9)
  v_mfma_f32_32x32x16_bf16 v[144:159], v[204:207], v[220:223], v[144:159]
  ds_read_b128 v[172:175], v83 offset:32768
  ds_read_b64_tr_b16 v[188:189], v7 offset:37888
  ds_read_b64_tr_b16 v[190:191], v7 offset:38144
  s_barrier
  s_waitcnt lgkmcnt(9)
  v_mfma_f32_32x32x16_bf16 v[144:159], v[160:163], v[176:179], v[144:159]
  ds_read_b128 v[192:195], v84 offset:32768
  ds_read_b64_tr_b16 v[208:209], v8 offset:32768
  ds_read_b64_tr_b16 v[210:211], v8 offset:33024
  s_waitcnt lgkmcnt(9)
  v_mfma_f32_32x32x16_bf16 v[144:159], v[164:167], v[180:183], v[144:159]
  ds_read_b128 v[196:199], v85 offset:32768
  ds_read_b64_tr_b16 v[212:213], v8 offset:33792
  ds_read_b64_tr_b16 v[214:215], v8 offset:34048
  s_waitcnt lgkmcnt(9)
  v_mfma_f32_32x32x16_bf16 v[144:159], v[168:171], v[184:187], v[144:159]
  ds_read_b128 v[200:203], v86 offset:32768
  ds_read_b64_tr_b16 v[216:217], v8 offset:36864
  ds_read_b64_tr_b16 v[218:219], v8 offset:37120
  s_waitcnt lgkmcnt(9)
  v_mfma_f32_32x32x16_bf16 v[144:159], v[172:175], v[188:191], v[144:159]
  ds_read_b128 v[204:207], v87 offset:32768
  ds_read_b64_tr_b16 v[220:221], v8 offset:37888
  ds_read_b64_tr_b16 v[222:223], v8 offset:38144
  s_barrier
  s_waitcnt lgkmcnt(9)
  v_mfma_f32_32x32x16_bf16 v[144:159], v[192:195], v[208:211], v[144:159]
  ds_read_b128 v[160:163], v88 offset:0
  ds_read_b64_tr_b16 v[176:177], v9 offset:0
  ds_read_b64_tr_b16 v[178:179], v9 offset:256
  s_waitcnt lgkmcnt(9)
  v_mfma_f32_32x32x16_bf16 v[144:159], v[196:199], v[212:215], v[144:159]
  ds_read_b128 v[164:167], v89 offset:0
  ds_read_b64_tr_b16 v[180:181], v9 offset:1024
  ds_read_b64_tr_b16 v[182:183], v9 offset:1280
  s_waitcnt lgkmcnt(9)
  v_mfma_f32_32x32x16_bf16 v[144:159], v[200:203], v[216:219], v[144:159]
  ds_read_b128 v[168:171], v90 offset:0
  ds_read_b64_tr_b16 v[184:185], v9 offset:4096
  ds_read_b64_tr_b16 v[186:187], v9 offset:4352
  s_waitcnt lgkmcnt(9)
  v_mfma_f32_32x32x16_bf16 v[144:159], v[204:207], v[220:223], v[144:159]
  ds_read_b128 v[172:175], v91 offset:0
  ds_read_b64_tr_b16 v[188:189], v9 offset:5120
  ds_read_b64_tr_b16 v[190:191], v9 offset:5376
  s_waitcnt vmcnt(1)
  s_barrier
  s_waitcnt lgkmcnt(9)
  v_mfma_f32_32x32x16_bf16 v[144:159], v[160:163], v[176:179], v[144:159]
  ds_read_b64_tr_b16 v[192:193], v5 offset:49152
  ds_read_b64_tr_b16 v[194:195], v5 offset:50176
  ds_read_b128 v[208:211], v93 offset:49152
  v_mul_f32 v68, v225, v225
  v_mul_f32 v69, 0xbfb8aa3b, v68
  s_waitcnt lgkmcnt(9)
  v_mfma_f32_32x32x16_bf16 v[144:159], v[164:167], v[180:183], v[144:159]
  ds_read_b64_tr_b16 v[196:197], v5 offset:53248
  ds_read_b64_tr_b16 v[198:199], v5 offset:54272
  ds_read_b128 v[212:215], v93 offset:50176
  v_lshlrev_b32 v32, 16, v226
  v_and_b32 v33, 0xffff0000, v226
  v_sub_f32 v64, v32, v224
  v_sub_f32 v65, v33, v224
  v_cvt_pk_bf16_f32 v66, v64, v65
  s_waitcnt lgkmcnt(9)
  v_mfma_f32_32x32x16_bf16 v[144:159], v[168:171], v[184:187], v[144:159]
  ds_read_b64_tr_b16 v[200:201], v5 offset:57344
  ds_read_b64_tr_b16 v[202:203], v5 offset:58368
  ds_read_b128 v[216:219], v93 offset:53248
  s_waitcnt lgkmcnt(9)
  v_mfma_f32_32x32x16_bf16 v[144:159], v[172:175], v[188:191], v[144:159]
  ds_read_b64_tr_b16 v[204:205], v5 offset:61440
  ds_read_b64_tr_b16 v[206:207], v5 offset:62464
  ds_read_b128 v[220:223], v93 offset:54272
  s_barrier
  s_waitcnt lgkmcnt(9)
  v_mfma_f32_32x32x16_bf16 v[128:143], v[192:195], v[208:211], 0
  ds_read_b64_tr_b16 v[160:161], v4 offset:49152
  ds_read_b64_tr_b16 v[162:163], v4 offset:50176
  ds_read_b128 v[176:179], v92 offset:49152
  v_lshlrev_b32 v64, 16, v66
  v_and_b32 v65, 0xffff0000, v66
  v_mul_f32 v64, v64, v225
  v_mul_f32 v65, v65, v225
  v_cvt_pk_bf16_f32 v66, v64, v65
  s_waitcnt lgkmcnt(9)
  v_mfma_f32_32x32x16_bf16 v[128:143], v[196:199], v[212:215], v[128:143]
  ds_read_b64_tr_b16 v[164:165], v4 offset:53248
  ds_read_b64_tr_b16 v[166:167], v4 offset:54272
  ds_read_b128 v[180:183], v92 offset:50176
  v_lshlrev_b32 v64, 16, v66
  v_and_b32 v65, 0xffff0000, v66
  v_lshlrev_b32 v66, 16, v234
  v_and_b32 v67, 0xffff0000, v234
  v_mul_f32 v64, v64, v66
  s_waitcnt lgkmcnt(9)
  v_mfma_f32_32x32x16_bf16 v[128:143], v[200:203], v[216:219], v[128:143]
  ds_read_b64_tr_b16 v[168:169], v4 offset:57344
  ds_read_b64_tr_b16 v[170:171], v4 offset:58368
  ds_read_b128 v[184:187], v92 offset:53248
  s_waitcnt lgkmcnt(9)
  v_mfma_f32_32x32x16_bf16 v[128:143], v[204:207], v[220:223], v[128:143]
  ds_read_b64_tr_b16 v[172:173], v4 offset:61440
  ds_read_b64_tr_b16 v[174:175], v4 offset:62464
  ds_read_b128 v[188:191], v92 offset:54272
  s_barrier
  s_waitcnt lgkmcnt(9)
  v_mfma_f32_32x32x16_bf16 v[128:143], v[160:163], v[176:179], v[128:143]
  ds_read_b64_tr_b16 v[192:193], v5 offset:0
  ds_read_b64_tr_b16 v[194:195], v5 offset:1024
  ds_read_b128 v[208:211], v93 offset:0
  v_mul_f32 v65, v65, v67
  v_cvt_pk_bf16_f32 v66, v64, v65
  v_lshlrev_b32 v48, 16, v66
  v_and_b32 v49, 0xffff0000, v66
  s_waitcnt lgkmcnt(9)
  v_mfma_f32_32x32x16_bf16 v[128:143], v[164:167], v[180:183], v[128:143]
  ds_read_b64_tr_b16 v[196:197], v5 offset:4096
  ds_read_b64_tr_b16 v[198:199], v5 offset:5120
  ds_read_b128 v[212:215], v93 offset:1024
  v_lshlrev_b32 v34, 16, v227
  v_and_b32 v35, 0xffff0000, v227
  v_sub_f32 v64, v34, v224
  v_sub_f32 v65, v35, v224
  v_cvt_pk_bf16_f32 v66, v64, v65
  s_waitcnt lgkmcnt(9)
  v_mfma_f32_32x32x16_bf16 v[128:143], v[168:171], v[184:187], v[128:143]
  ds_read_b64_tr_b16 v[200:201], v5 offset:8192
  ds_read_b64_tr_b16 v[202:203], v5 offset:9216
  ds_read_b128 v[216:219], v93 offset:4096
  s_waitcnt lgkmcnt(9)
  v_mfma_f32_32x32x16_bf16 v[128:143], v[172:175], v[188:191], v[128:143]
  ds_read_b64_tr_b16 v[204:205], v5 offset:12288
  ds_read_b64_tr_b16 v[206:207], v5 offset:13312
  ds_read_b128 v[220:223], v93 offset:5120
  s_barrier
  s_waitcnt lgkmcnt(9)
  v_mfma_f32_32x32x16_bf16 v[128:143], v[192:195], v[208:211], v[128:143]
  ds_read_b64_tr_b16 v[160:161], v4 offset:0
  ds_read_b64_tr_b16 v[162:163], v4 offset:1024
  ds_read_b128 v[176:179], v92 offset:0
  v_lshlrev_b32 v64, 16, v66
  v_and_b32 v65, 0xffff0000, v66
  v_mul_f32 v64, v64, v225
  v_mul_f32 v65, v65, v225
  v_cvt_pk_bf16_f32 v66, v64, v65
  s_waitcnt lgkmcnt(9)
  v_mfma_f32_32x32x16_bf16 v[128:143], v[196:199], v[212:215], v[128:143]
  ds_read_b64_tr_b16 v[164:165], v4 offset:4096
  ds_read_b64_tr_b16 v[166:167], v4 offset:5120
  ds_read_b128 v[180:183], v92 offset:1024
  v_lshlrev_b32 v64, 16, v66
  v_and_b32 v65, 0xffff0000, v66
  v_lshlrev_b32 v66, 16, v235
  v_and_b32 v67, 0xffff0000, v235
  v_mul_f32 v64, v64, v66
  s_waitcnt lgkmcnt(9)
  v_mfma_f32_32x32x16_bf16 v[128:143], v[200:203], v[216:219], v[128:143]
  ds_read_b64_tr_b16 v[168:169], v4 offset:8192
  ds_read_b64_tr_b16 v[170:171], v4 offset:9216
  ds_read_b128 v[184:187], v92 offset:4096
  s_waitcnt lgkmcnt(9)
  v_mfma_f32_32x32x16_bf16 v[128:143], v[204:207], v[220:223], v[128:143]
  ds_read_b64_tr_b16 v[172:173], v4 offset:12288
  ds_read_b64_tr_b16 v[174:175], v4 offset:13312
  ds_read_b128 v[188:191], v92 offset:5120
  s_barrier
  s_waitcnt lgkmcnt(9)
  v_mfma_f32_32x32x16_bf16 v[128:143], v[160:163], v[176:179], v[128:143]
  ds_read_b64_tr_b16 v[192:193], v5 offset:16384
  ds_read_b64_tr_b16 v[194:195], v5 offset:17408
  ds_read_b128 v[208:211], v93 offset:16384
  v_mul_f32 v65, v65, v67
  v_cvt_pk_bf16_f32 v66, v64, v65
  v_lshlrev_b32 v50, 16, v66
  v_and_b32 v51, 0xffff0000, v66
  s_waitcnt lgkmcnt(9)
  v_mfma_f32_32x32x16_bf16 v[128:143], v[164:167], v[180:183], v[128:143]
  ds_read_b64_tr_b16 v[196:197], v5 offset:20480
  ds_read_b64_tr_b16 v[198:199], v5 offset:21504
  ds_read_b128 v[212:215], v93 offset:17408
  v_lshlrev_b32 v36, 16, v228
  v_and_b32 v37, 0xffff0000, v228
  v_sub_f32 v64, v36, v224
  v_sub_f32 v65, v37, v224
  v_cvt_pk_bf16_f32 v66, v64, v65
  s_waitcnt lgkmcnt(9)
  v_mfma_f32_32x32x16_bf16 v[128:143], v[168:171], v[184:187], v[128:143]
  ds_read_b64_tr_b16 v[200:201], v5 offset:24576
  ds_read_b64_tr_b16 v[202:203], v5 offset:25600
  ds_read_b128 v[216:219], v93 offset:20480
  s_waitcnt lgkmcnt(9)
  v_mfma_f32_32x32x16_bf16 v[128:143], v[172:175], v[188:191], v[128:143]
  ds_read_b64_tr_b16 v[204:205], v5 offset:28672
  ds_read_b64_tr_b16 v[206:207], v5 offset:29696
  ds_read_b128 v[220:223], v93 offset:21504
  s_barrier
  s_waitcnt lgkmcnt(9)
  v_mfma_f32_32x32x16_bf16 v[128:143], v[192:195], v[208:211], v[128:143]
  ds_read_b64_tr_b16 v[160:161], v4 offset:16384
  ds_read_b64_tr_b16 v[162:163], v4 offset:17408
  ds_read_b128 v[176:179], v92 offset:16384
  v_lshlrev_b32 v64, 16, v66
  v_and_b32 v65, 0xffff0000, v66
  v_mul_f32 v64, v64, v225
  v_mul_f32 v65, v65, v225
  v_cvt_pk_bf16_f32 v66, v64, v65
  s_waitcnt lgkmcnt(9)
  v_mfma_f32_32x32x16_bf16 v[128:143], v[196:199], v[212:215], v[128:143]
  ds_read_b64_tr_b16 v[164:165], v4 offset:20480
  ds_read_b64_tr_b16 v[166:167], v4 offset:21504
  ds_read_b128 v[180:183], v92 offset:17408
  v_lshlrev_b32 v64, 16, v66
  v_and_b32 v65, 0xffff0000, v66
  v_lshlrev_b32 v66, 16, v236
  v_and_b32 v67, 0xffff0000, v236
  v_mul_f32 v64, v64, v66
  s_waitcnt lgkmcnt(9)
  v_mfma_f32_32x32x16_bf16 v[128:143], v[200:203], v[216:219], v[128:143]
  ds_read_b64_tr_b16 v[168:169], v4 offset:24576
  ds_read_b64_tr_b16 v[170:171], v4 offset:25600
  ds_read_b128 v[184:187], v92 offset:20480
  buffer_load_dword v25, v23, s[8:11], s75 offen sc1
  s_waitcnt lgkmcnt(9)
  v_mfma_f32_32x32x16_bf16 v[128:143], v[204:207], v[220:223], v[128:143]
  ds_read_b64_tr_b16 v[172:173], v4 offset:28672
  ds_read_b64_tr_b16 v[174:175], v4 offset:29696
  ds_read_b128 v[188:191], v92 offset:21504
  s_barrier
  s_waitcnt lgkmcnt(9)
  v_mfma_f32_32x32x16_bf16 v[128:143], v[160:163], v[176:179], v[128:143]
  ds_read_b64_tr_b16 v[192:193], v4 offset:32768
  ds_read_b64_tr_b16 v[194:195], v4 offset:33792
  ds_read_b128 v[208:211], v92 offset:32768
  v_mul_f32 v65, v65, v67
  v_cvt_pk_bf16_f32 v66, v64, v65
  v_lshlrev_b32 v52, 16, v66
  v_and_b32 v53, 0xffff0000, v66
  s_waitcnt lgkmcnt(9)
  v_mfma_f32_32x32x16_bf16 v[128:143], v[164:167], v[180:183], v[128:143]
  ds_read_b64_tr_b16 v[196:197], v4 offset:36864
  ds_read_b64_tr_b16 v[198:199], v4 offset:37888
  ds_read_b128 v[212:215], v92 offset:33792
  v_lshlrev_b32 v38, 16, v229
  v_and_b32 v39, 0xffff0000, v229
  v_sub_f32 v64, v38, v224
  v_sub_f32 v65, v39, v224
  v_cvt_pk_bf16_f32 v66, v64, v65
  s_waitcnt lgkmcnt(9)
  v_mfma_f32_32x32x16_bf16 v[128:143], v[168:171], v[184:187], v[128:143]
  ds_read_b64_tr_b16 v[200:201], v4 offset:40960
  ds_read_b64_tr_b16 v[202:203], v4 offset:41984
  ds_read_b128 v[216:219], v92 offset:36864
  s_waitcnt lgkmcnt(9)
  v_mfma_f32_32x32x16_bf16 v[128:143], v[172:175], v[188:191], v[128:143]
  ds_read_b64_tr_b16 v[204:205], v4 offset:45056
  ds_read_b64_tr_b16 v[206:207], v4 offset:46080
  ds_read_b128 v[220:223], v92 offset:37888
  s_barrier
  s_waitcnt lgkmcnt(9)
  v_mfma_f32_32x32x16_bf16 v[128:143], v[192:195], v[208:211], v[128:143]
  ds_read_b64_tr_b16 v[160:161], v5 offset:32768
  ds_read_b64_tr_b16 v[162:163], v5 offset:33792
  ds_read_b128 v[176:179], v93 offset:32768
  v_lshlrev_b32 v64, 16, v66
  v_and_b32 v65, 0xffff0000, v66
  v_mul_f32 v64, v64, v225
  v_mul_f32 v65, v65, v225
  v_cvt_pk_bf16_f32 v66, v64, v65
  s_waitcnt lgkmcnt(9)
  v_mfma_f32_32x32x16_bf16 v[128:143], v[196:199], v[212:215], v[128:143]
  ds_read_b64_tr_b16 v[164:165], v5 offset:36864
  ds_read_b64_tr_b16 v[166:167], v5 offset:37888
  ds_read_b128 v[180:183], v93 offset:33792
  v_lshlrev_b32 v64, 16, v66
  v_and_b32 v65, 0xffff0000, v66
  v_lshlrev_b32 v66, 16, v237
  v_and_b32 v67, 0xffff0000, v237
  v_mul_f32 v64, v64, v66
  s_waitcnt lgkmcnt(9)
  v_mfma_f32_32x32x16_bf16 v[128:143], v[200:203], v[216:219], v[128:143]
  ds_read_b64_tr_b16 v[168:169], v5 offset:40960
  ds_read_b64_tr_b16 v[170:171], v5 offset:41984
  ds_read_b128 v[184:187], v93 offset:36864
  s_waitcnt lgkmcnt(9)
  v_mfma_f32_32x32x16_bf16 v[128:143], v[204:207], v[220:223], v[128:143]
  ds_read_b64_tr_b16 v[172:173], v5 offset:45056
  ds_read_b64_tr_b16 v[174:175], v5 offset:46080
  ds_read_b128 v[188:191], v93 offset:37888
  s_barrier
  s_waitcnt lgkmcnt(9)
  v_mfma_f32_32x32x16_bf16 v[128:143], v[160:163], v[176:179], v[128:143]
  ds_read_b64_tr_b16 v[192:193], v6 offset:0
  ds_read_b64_tr_b16 v[194:195], v6 offset:1024
  ds_read_b128 v[208:211], v94 offset:0
  v_mul_f32 v65, v65, v67
  v_cvt_pk_bf16_f32 v66, v64, v65
  v_lshlrev_b32 v54, 16, v66
  v_and_b32 v55, 0xffff0000, v66
  s_waitcnt lgkmcnt(9)
  v_mfma_f32_32x32x16_bf16 v[128:143], v[164:167], v[180:183], v[128:143]
  ds_read_b64_tr_b16 v[196:197], v6 offset:4096
  ds_read_b64_tr_b16 v[198:199], v6 offset:5120
  ds_read_b128 v[212:215], v94 offset:1024
  v_lshlrev_b32 v40, 16, v230
  v_and_b32 v41, 0xffff0000, v230
  v_sub_f32 v64, v40, v224
  v_sub_f32 v65, v41, v224
  v_cvt_pk_bf16_f32 v66, v64, v65
  s_waitcnt lgkmcnt(9)
  v_mfma_f32_32x32x16_bf16 v[128:143], v[168:171], v[184:187], v[128:143]
  ds_read_b64_tr_b16 v[200:201], v6 offset:8192
  ds_read_b64_tr_b16 v[202:203], v6 offset:9216
  ds_read_b128 v[216:219], v94 offset:4096
  s_waitcnt vmcnt(0)
  v_cmp_ne_u32 vcc, s66, v25
  s_and_b64 vcc, vcc, s[96:97]
  s_cbranch_vccnz L_fb2_s
L_fb2_k:
  s_waitcnt lgkmcnt(9)
  v_mfma_f32_32x32x16_bf16 v[128:143], v[172:175], v[188:191], v[128:143]
  ds_read_b64_tr_b16 v[204:205], v6 offset:12288
  ds_read_b64_tr_b16 v[206:207], v6 offset:13312
  ds_read_b128 v[220:223], v94 offset:5120
  s_barrier
  s_waitcnt lgkmcnt(9)
  v_mfma_f32_32x32x16_bf16 v[128:143], v[192:195], v[208:211], v[128:143]
  ds_read_b64_tr_b16 v[160:161], v5 offset:49152
  ds_read_b64_tr_b16 v[162:163], v5 offset:50176
  ds_read_b128 v[176:179], v93 offset:49152
  v_lshlrev_b32 v64, 16, v66
  v_and_b32 v65, 0xffff0000, v66
  v_mul_f32 v64, v64, v225
  v_mul_f32 v65, v65, v225
  v_cvt_pk_bf16_f32 v66, v64, v65
  s_waitcnt lgkmcnt(9)
  v_mfma_f32_32x32x16_bf16 v[128:143], v[196:199], v[212:215], v[128:143]
  ds_read_b64_tr_b16 v[164:165], v5 offset:53248
  ds_read_b64_tr_b16 v[166:167], v5 offset:54272
  ds_read_b128 v[180:183], v93 offset:50176
  v_lshlrev_b32 v64, 16, v66
  v_and_b32 v65, 0xffff0000, v66
  v_lshlrev_b32 v66, 16, v238
  v_and_b32 v67, 0xffff0000, v238
  v_mul_f32 v64, v64, v66
  s_waitcnt lgkmcnt(9)
  v_mfma_f32_32x32x16_bf16 v[128:143], v[200:203], v[216:219], v[128:143]
  ds_read_b64_tr_b16 v[168:169], v5 offset:57344
  ds_read_b64_tr_b16 v[170:171], v5 offset:58368
  ds_read_b128 v[184:187], v93 offset:53248
  s_waitcnt lgkmcnt(9)
  v_mfma_f32_32x32x16_bf16 v[128:143], v[204:207], v[220:223], v[128:143]
  ds_read_b64_tr_b16 v[172:173], v5 offset:61440
  ds_read_b64_tr_b16 v[174:175], v5 offset:62464
  ds_read_b128 v[188:191], v93 offset:54272
  s_barrier
  s_waitcnt lgkmcnt(9)
  v_mfma_f32_32x32x16_bf16 v[128:143], v[160:163], v[176:179], v[128:143]
  ds_read_b64_tr_b16 v[192:193], v4 offset:49152
  ds_read_b64_tr_b16 v[194:195], v4 offset:50176
  ds_read_b128 v[208:211], v92 offset:49152
  v_mul_f32 v65, v65, v67
  v_cvt_pk_bf16_f32 v66, v64, v65
  v_lshlrev_b32 v56, 16, v66
  v_and_b32 v57, 0xffff0000, v66
  s_waitcnt lgkmcnt(9)
  v_mfma_f32_32x32x16_bf16 v[128:143], v[164:167], v[180:183], v[128:143]
  ds_read_b64_tr_b16 v[196:197], v4 offset:53248
  ds_read_b64_tr_b16 v[198:199], v4 offset:54272
  ds_read_b128 v[212:215], v92 offset:50176
  v_lshlrev_b32 v42, 16, v231
  v_and_b32 v43, 0xffff0000, v231
  v_sub_f32 v64, v42, v224
  v_sub_f32 v65, v43, v224
  v_cvt_pk_bf16_f32 v66, v64, v65
  s_waitcnt lgkmcnt(9)
  v_mfma_f32_32x32x16_bf16 v[128:143], v[168:171], v[184:187], v[128:143]
  ds_read_b64_tr_b16 v[200:201], v4 offset:57344
  ds_read_b64_tr_b16 v[202:203], v4 offset:58368
  ds_read_b128 v[216:219], v92 offset:53248
  s_waitcnt lgkmcnt(9)
  v_mfma_f32_32x32x16_bf16 v[128:143], v[172:175], v[188:191], v[128:143]
  ds_read_b64_tr_b16 v[204:205], v4 offset:61440
  ds_read_b64_tr_b16 v[206:207], v4 offset:62464
  ds_read_b128 v[220:223], v92 offset:54272
  s_barrier
  s_waitcnt lgkmcnt(9)
  v_mfma_f32_32x32x16_bf16 v[128:143], v[192:195], v[208:211], v[128:143]
  ds_read_b64_tr_b16 v[160:161], v5 offset:0
  ds_read_b64_tr_b16 v[162:163], v5 offset:1024
  ds_read_b128 v[176:179], v93 offset:0
  v_lshlrev_b32 v64, 16, v66
  v_and_b32 v65, 0xffff0000, v66
  v_mul_f32 v64, v64, v225
  v_mul_f32 v65, v65, v225
  v_cvt_pk_bf16_f32 v66, v64, v65
  s_waitcnt lgkmcnt(9)
  v_mfma_f32_32x32x16_bf16 v[128:143], v[196:199], v[212:215], v[128:143]
  ds_read_b64_tr_b16 v[164:165], v5 offset:4096
  ds_read_b64_tr_b16 v[166:167], v5 offset:5120
  ds_read_b128 v[180:183], v93 offset:1024
  v_lshlrev_b32 v64, 16, v66
  v_and_b32 v65, 0xffff0000, v66
  v_lshlrev_b32 v66, 16, v239
  v_and_b32 v67, 0xffff0000, v239
  v_mul_f32 v64, v64, v66
  s_waitcnt lgkmcnt(9)
  v_mfma_f32_32x32x16_bf16 v[128:143], v[200:203], v[216:219], v[128:143]
  ds_read_b64_tr_b16 v[168:169], v5 offset:8192
  ds_read_b64_tr_b16 v[170:171], v5 offset:9216
  ds_read_b128 v[184:187], v93 offset:4096
  s_waitcnt lgkmcnt(9)
  v_mfma_f32_32x32x16_bf16 v[128:143], v[204:207], v[220:223], v[128:143]
  ds_read_b64_tr_b16 v[172:173], v5 offset:12288
  ds_read_b64_tr_b16 v[174:175], v5 offset:13312
  ds_read_b128 v[188:191], v93 offset:5120
  s_barrier
  s_waitcnt lgkmcnt(9)
  v_mfma_f32_32x32x16_bf16 v[128:143], v[160:163], v[176:179], v[128:143]
  ds_read_b64_tr_b16 v[192:193], v4 offset:0
  ds_read_b64_tr_b16 v[194:195], v4 offset:1024
  ds_read_b128 v[208:211], v92 offset:0
  v_mul_f32 v65, v65, v67
  v_cvt_pk_bf16_f32 v66, v64, v65
  v_lshlrev_b32 v58, 16, v66
  v_and_b32 v59, 0xffff0000, v66
  s_waitcnt lgkmcnt(9)
  v_mfma_f32_32x32x16_bf16 v[128:143], v[164:167], v[180:183], v[128:143]
  ds_read_b64_tr_b16 v[196:197], v4 offset:4096
  ds_read_b64_tr_b16 v[198:199], v4 offset:5120
  ds_read_b128 v[212:215], v92 offset:1024
  v_lshlrev_b32 v44, 16, v232
  v_and_b32 v45, 0xffff0000, v232
  v_sub_f32 v64, v44, v224
  v_sub_f32 v65, v45, v224
  v_cvt_pk_bf16_f32 v66, v64, v65
  s_waitcnt lgkmcnt(9)
  v_mfma_f32_32x32x16_bf16 v[128:143], v[168:171], v[184:187], v[128:143]
  ds_read_b64_tr_b16 v[200:201], v4 offset:8192
  ds_read_b64_tr_b16 v[202:203], v4 offset:9216
  ds_read_b128 v[216:219], v92 offset:4096
  s_waitcnt lgkmcnt(9)
  v_mfma_f32_32x32x16_bf16 v[128:143], v[172:175], v[188:191], v[128:143]
  ds_read_b64_tr_b16 v[204:205], v4 offset:12288
  ds_read_b64_tr_b16 v[206:207], v4 offset:13312
  ds_read_b128 v[220:223], v92 offset:5120
  s_barrier
  s_waitcnt lgkmcnt(9)
  v_mfma_f32_32x32x16_bf16 v[128:143], v[192:195], v[208:211], v[128:143]
  ds_read_b64_tr_b16 v[160:161], v5 offset:16384
  ds_read_b64_tr_b16 v[162:163], v5 offset:17408
  ds_read_b128 v[176:179], v93 offset:16384
  v_lshlrev_b32 v64, 16, v66
  v_and_b32 v65, 0xffff0000, v66
  v_mul_f32 v64, v64, v225
  v_mul_f32 v65, v65, v225
  v_cvt_pk_bf16_f32 v66, v64, v65
  s_waitcnt lgkmcnt(9)
  v_mfma_f32_32x32x16_bf16 v[128:143], v[196:199], v[212:215], v[128:143]
  ds_read_b64_tr_b16 v[164:165], v5 offset:20480
  ds_read_b64_tr_b16 v[166:167], v5 offset:21504
  ds_read_b128 v[180:183], v93 offset:17408
  v_lshlrev_b32 v64, 16, v66
  v_and_b32 v65, 0xffff0000, v66
  v_lshlrev_b32 v66, 16, v240
  v_and_b32 v67, 0xffff0000, v240
  v_mul_f32 v64, v64, v66
  s_waitcnt lgkmcnt(9)
  v_mfma_f32_32x32x16_bf16 v[128:143], v[200:203], v[216:219], v[128:143]
  ds_read_b64_tr_b16 v[168:169], v5 offset:24576
  ds_read_b64_tr_b16 v[170:171], v5 offset:25600
  ds_read_b128 v[184:187], v93 offset:20480
  s_waitcnt lgkmcnt(9)
  v_mfma_f32_32x32x16_bf16 v[128:143], v[204:207], v[220:223], v[128:143]
  ds_read_b64_tr_b16 v[172:173], v5 offset:28672
  ds_read_b64_tr_b16 v[174:175], v5 offset:29696
  ds_read_b128 v[188:191], v93 offset:21504
  s_barrier
  s_waitcnt lgkmcnt(9)
  v_mfma_f32_32x32x16_bf16 v[128:143], v[160:163], v[176:179], v[128:143]
  ds_read_b64_tr_b16 v[192:193], v4 offset:16384
  ds_read_b64_tr_b16 v[194:195], v4 offset:17408
  ds_read_b128 v[208:211], v92 offset:16384
  v_mul_f32 v65, v65, v67
  v_cvt_pk_bf16_f32 v66, v64, v65
  v_lshlrev_b32 v60, 16, v66
  v_and_b32 v61, 0xffff0000, v66
  s_waitcnt lgkmcnt(9)
  v_mfma_f32_32x32x16_bf16 v[128:143], v[164:167], v[180:183], v[128:143]
  ds_read_b64_tr_b16 v[196:197], v4 offset:20480
  ds_read_b64_tr_b16 v[198:199], v4 offset:21504
  ds_read_b128 v[212:215], v92 offset:17408
  v_lshlrev_b32 v46, 16, v233
  v_and_b32 v47, 0xffff0000, v233
  v_sub_f32 v64, v46, v224
  v_sub_f32 v65, v47, v224
  v_cvt_pk_bf16_f32 v66, v64, v65
  s_waitcnt lgkmcnt(9)
  v_mfma_f32_32x32x16_bf16 v[128:143], v[168:171], v[184:187], v[128:143]
  ds_read_b64_tr_b16 v[200:201], v4 offset:24576
  ds_read_b64_tr_b16 v[202:203], v4 offset:25600
  ds_read_b128 v[216:219], v92 offset:20480
  s_waitcnt lgkmcnt(9)
  v_mfma_f32_32x32x16_bf16 v[128:143], v[172:175], v[188:191], v[128:143]
  ds_read_b64_tr_b16 v[204:205], v4 offset:28672
  ds_read_b64_tr_b16 v[206:207], v4 offset:29696
  ds_read_b128 v[220:223], v92 offset:21504
  s_barrier
  s_waitcnt lgkmcnt(9)
  v_mfma_f32_32x32x16_bf16 v[128:143], v[192:195], v[208:211], v[128:143]
  ds_read_b64_tr_b16 v[160:161], v4 offset:32768
  ds_read_b64_tr_b16 v[162:163], v4 offset:33792
  ds_read_b128 v[176:179], v92 offset:32768
  v_lshlrev_b32 v64, 16, v66
  v_and_b32 v65, 0xffff0000, v66
  v_mul_f32 v64, v64, v225
  v_mul_f32 v65, v65, v225
  v_cvt_pk_bf16_f32 v66, v64, v65
  s_waitcnt lgkmcnt(9)
  v_mfma_f32_32x32x16_bf16 v[128:143], v[196:199], v[212:215], v[128:143]
  ds_read_b64_tr_b16 v[164:165], v4 offset:36864
  ds_read_b64_tr_b16 v[166:167], v4 offset:37888
  ds_read_b128 v[180:183], v92 offset:33792
  v_lshlrev_b32 v64, 16, v66
  v_and_b32 v65, 0xffff0000, v66
  v_lshlrev_b32 v66, 16, v241
  v_and_b32 v67, 0xffff0000, v241
  v_mul_f32 v64, v64, v66
  s_waitcnt lgkmcnt(9)
  v_mfma_f32_32x32x16_bf16 v[128:143], v[200:203], v[216:219], v[128:143]
  ds_read_b64_tr_b16 v[168:169], v4 offset:40960
  ds_read_b64_tr_b16 v[170:171], v4 offset:41984
  ds_read_b128 v[184:187], v92 offset:36864
  s_waitcnt lgkmcnt(9)
  v_mfma_f32_32x32x16_bf16 v[128:143], v[204:207], v[220:223], v[128:143]
  ds_read_b64_tr_b16 v[172:173], v4 offset:45056
  ds_read_b64_tr_b16 v[174:175], v4 offset:46080
  ds_read_b128 v[188:191], v92 offset:37888
  s_barrier
  s_waitcnt lgkmcnt(9)
  v_mfma_f32_32x32x16_bf16 v[128:143], v[160:163], v[176:179], v[128:143]
  ds_read_b64_tr_b16 v[192:193], v5 offset:32768
  ds_read_b64_tr_b16 v[194:195], v5 offset:33792
  ds_read_b128 v[208:211], v93 offset:32768
  v_mul_f32 v65, v65, v67
  v_cvt_pk_bf16_f32 v66, v64, v65
  v_lshlrev_b32 v62, 16, v66
  v_and_b32 v63, 0xffff0000, v66
  s_waitcnt lgkmcnt(9)
  v_mfma_f32_32x32x16_bf16 v[128:143], v[164:167], v[180:183], v[128:143]
  ds_read_b64_tr_b16 v[196:197], v5 offset:36864
  ds_read_b64_tr_b16 v[198:199], v5 offset:37888
  ds_read_b128 v[212:215], v93 offset:33792
  s_waitcnt lgkmcnt(9)
  v_mfma_f32_32x32x16_bf16 v[128:143], v[168:171], v[184:187], v[128:143]
  ds_read_b64_tr_b16 v[200:201], v5 offset:40960
  ds_read_b64_tr_b16 v[202:203], v5 offset:41984
  ds_read_b128 v[216:219], v93 offset:36864
  s_waitcnt lgkmcnt(9)
  v_mfma_f32_32x32x16_bf16 v[128:143], v[172:175], v[188:191], v[128:143]
  ds_read_b64_tr_b16 v[204:205], v5 offset:45056
  ds_read_b64_tr_b16 v[206:207], v5 offset:46080
  ds_read_b128 v[220:223], v93 offset:37888
  s_barrier
  s_waitcnt lgkmcnt(9)
  v_mfma_f32_32x32x16_bf16 v[128:143], v[192:195], v[208:211], v[128:143]
  ds_read_b64_tr_b16 v[160:161], v6 offset:0
  ds_read_b64_tr_b16 v[162:163], v6 offset:1024
  ds_read_b128 v[176:179], v94 offset:0
  s_waitcnt lgkmcnt(9)
  v_mfma_f32_32x32x16_bf16 v[128:143], v[196:199], v[212:215], v[128:143]
  ds_read_b64_tr_b16 v[164:165], v6 offset:4096
  ds_read_b64_tr_b16 v[166:167], v6 offset:5120
  ds_read_b128 v[180:183], v94 offset:1024
  s_waitcnt lgkmcnt(9)
  v_mfma_f32_32x32x16_bf16 v[128:143], v[200:203], v[216:219], v[128:143]
  ds_read_b64_tr_b16 v[168:169], v6 offset:8192
  ds_read_b64_tr_b16 v[170:171], v6 offset:9216
  ds_read_b128 v[184:187], v94 offset:4096
  s_waitcnt lgkmcnt(9)
  v_mfma_f32_32x32x16_bf16 v[128:143], v[204:207], v[220:223], v[128:143]
  ds_read_b64_tr_b16 v[172:173], v6 offset:12288
  ds_read_b64_tr_b16 v[174:175], v6 offset:13312
  ds_read_b128 v[188:191], v94 offset:5120
  s_barrier
  s_waitcnt lgkmcnt(9)
  v_mfma_f32_32x32x16_bf16 v[128:143], v[160:163], v[176:179], v[128:143]
  ds_read_b64_tr_b16 v[192:193], v5 offset:49152
  ds_read_b64_tr_b16 v[194:195], v5 offset:50176
  ds_read_b128 v[208:211], v93 offset:49152
  s_waitcnt lgkmcnt(9)
  v_mfma_f32_32x32x16_bf16 v[128:143], v[164:167], v[180:183], v[128:143]
  ds_read_b64_tr_b16 v[196:197], v5 offset:53248
  ds_read_b64_tr_b16 v[198:199], v5 offset:54272
  ds_read_b128 v[212:215], v93 offset:50176
  s_waitcnt lgkmcnt(9)
  v_mfma_f32_32x32x16_bf16 v[128:143], v[168:171], v[184:187], v[128:143]
  ds_read_b64_tr_b16 v[200:201], v5 offset:57344
  ds_read_b64_tr_b16 v[202:203], v5 offset:58368
  ds_read_b128 v[216:219], v93 offset:53248
  s_waitcnt lgkmcnt(9)
  v_mfma_f32_32x32x16_bf16 v[128:143], v[172:175], v[188:191], v[128:143]
  ds_read_b64_tr_b16 v[204:205], v5 offset:61440
  ds_read_b64_tr_b16 v[206:207], v5 offset:62464
  ds_read_b128 v[220:223], v93 offset:54272
  s_barrier
  s_waitcnt lgkmcnt(9)
  v_mfma_f32_32x32x16_bf16 v[128:143], v[192:195], v[208:211], v[128:143]
  ds_read_b64_tr_b16 v[160:161], v4 offset:49152
  ds_read_b64_tr_b16 v[162:163], v4 offset:50176
  ds_read_b128 v[176:179], v92 offset:49152
  s_waitcnt lgkmcnt(9)
  v_mfma_f32_32x32x16_bf16 v[128:143], v[196:199], v[212:215], v[128:143]
  ds_read_b64_tr_b16 v[164:165], v4 offset:53248
  ds_read_b64_tr_b16 v[166:167], v4 offset:54272
  ds_read_b128 v[180:183], v92 offset:50176
  s_waitcnt lgkmcnt(9)
  v_mfma_f32_32x32x16_bf16 v[128:143], v[200:203], v[216:219], v[128:143]
  ds_read_b64_tr_b16 v[168:169], v4 offset:57344
  ds_read_b64_tr_b16 v[170:171], v4 offset:58368
  ds_read_b128 v[184:187], v92 offset:53248
  s_waitcnt lgkmcnt(9)
  v_mfma_f32_32x32x16_bf16 v[128:143], v[204:207], v[220:223], v[128:143]
  ds_read_b64_tr_b16 v[172:173], v4 offset:61440
  ds_read_b64_tr_b16 v[174:175], v4 offset:62464
  ds_read_b128 v[188:191], v92 offset:54272
  s_barrier
  s_waitcnt lgkmcnt(9)
  v_mfma_f32_32x32x16_bf16 v[128:143], v[160:163], v[176:179], v[128:143]
  ds_read_b64_tr_b16 v[192:193], v5 offset:0
  ds_read_b64_tr_b16 v[194:195], v5 offset:1024
  ds_read_b128 v[208:211], v93 offset:0
  s_waitcnt lgkmcnt(9)
  v_mfma_f32_32x32x16_bf16 v[128:143], v[164:167], v[180:183], v[128:143]
  ds_read_b64_tr_b16 v[196:197], v5 offset:4096
  ds_read_b64_tr_b16 v[198:199], v5 offset:5120
  ds_read_b128 v[212:215], v93 offset:1024
  s_waitcnt lgkmcnt(9)
  v_mfma_f32_32x32x16_bf16 v[128:143], v[168:171], v[184:187], v[128:143]
  ds_read_b64_tr_b16 v[200:201], v5 offset:8192
  ds_read_b64_tr_b16 v[202:203], v5 offset:9216
  ds_read_b128 v[216:219], v93 offset:4096
  s_waitcnt lgkmcnt(9)
  v_mfma_f32_32x32x16_bf16 v[128:143], v[172:175], v[188:191], v[128:143]
  ds_read_b64_tr_b16 v[204:205], v5 offset:12288
  ds_read_b64_tr_b16 v[206:207], v5 offset:13312
  ds_read_b128 v[220:223], v93 offset:5120
  s_barrier
  s_waitcnt lgkmcnt(9)
  v_mfma_f32_32x32x16_bf16 v[128:143], v[192:195], v[208:211], v[128:143]
  ds_read_b64_tr_b16 v[160:161], v4 offset:0
  ds_read_b64_tr_b16 v[162:163], v4 offset:1024
  ds_read_b128 v[176:179], v92 offset:0
  s_waitcnt lgkmcnt(9)
  v_mfma_f32_32x32x16_bf16 v[128:143], v[196:199], v[212:215], v[128:143]
  ds_read_b64_tr_b16 v[164:165], v4 offset:4096
  ds_read_b64_tr_b16 v[166:167], v4 offset:5120
  ds_read_b128 v[180:183], v92 offset:1024
  s_waitcnt lgkmcnt(9)
  v_mfma_f32_32x32x16_bf16 v[128:143], v[200:203], v[216:219], v[128:143]
  ds_read_b64_tr_b16 v[168:169], v4 offset:8192
  ds_read_b64_tr_b16 v[170:171], v4 offset:9216
  ds_read_b128 v[184:187], v92 offset:4096
  s_waitcnt lgkmcnt(9)
  v_mfma_f32_32x32x16_bf16 v[128:143], v[204:207], v[220:223], v[128:143]
  ds_read_b64_tr_b16 v[172:173], v4 offset:12288
  ds_read_b64_tr_b16 v[174:175], v4 offset:13312
  ds_read_b128 v[188:191], v92 offset:5120
  s_barrier
  s_waitcnt lgkmcnt(9)
  v_mfma_f32_32x32x16_bf16 v[128:143], v[160:163], v[176:179], v[128:143]
  ds_read_b64_tr_b16 v[192:193], v5 offset:16384
  ds_read_b64_tr_b16 v[194:195], v5 offset:17408
  ds_read_b128 v[208:211], v93 offset:16384
  s_waitcnt lgkmcnt(9)
  v_mfma_f32_32x32x16_bf16 v[128:143], v[164:167], v[180:183], v[128:143]
  ds_read_b64_tr_b16 v[196:197], v5 offset:20480
  ds_read_b64_tr_b16 v[198:199], v5 offset:21504
  ds_read_b128 v[212:215], v93 offset:17408
  s_waitcnt lgkmcnt(9)
  v_mfma_f32_32x32x16_bf16 v[128:143], v[168:171], v[184:187], v[128:143]
  ds_read_b64_tr_b16 v[200:201], v5 offset:24576
  ds_read_b64_tr_b16 v[202:203], v5 offset:25600
  ds_read_b128 v[216:219], v93 offset:20480
  s_waitcnt lgkmcnt(9)
  v_mfma_f32_32x32x16_bf16 v[128:143], v[172:175], v[188:191], v[128:143]
  ds_read_b64_tr_b16 v[204:205], v5 offset:28672
  ds_read_b64_tr_b16 v[206:207], v5 offset:29696
  ds_read_b128 v[220:223], v93 offset:21504
  s_barrier
  s_waitcnt lgkmcnt(9)
  v_mfma_f32_32x32x16_bf16 v[128:143], v[192:195], v[208:211], v[128:143]
  ds_read_b64_tr_b16 v[160:161], v4 offset:16384
  ds_read_b64_tr_b16 v[162:163], v4 offset:17408
  ds_read_b128 v[176:179], v92 offset:16384
  s_waitcnt lgkmcnt(9)
  v_mfma_f32_32x32x16_bf16 v[128:143], v[196:199], v[212:215], v[128:143]
  ds_read_b64_tr_b16 v[164:165], v4 offset:20480
  ds_read_b64_tr_b16 v[166:167], v4 offset:21504
  ds_read_b128 v[180:183], v92 offset:17408
  s_waitcnt lgkmcnt(9)
  v_mfma_f32_32x32x16_bf16 v[128:143], v[200:203], v[216:219], v[128:143]
  ds_read_b64_tr_b16 v[168:169], v4 offset:24576
  ds_read_b64_tr_b16 v[170:171], v4 offset:25600
  ds_read_b128 v[184:187], v92 offset:20480
  s_waitcnt lgkmcnt(9)
  v_mfma_f32_32x32x16_bf16 v[128:143], v[204:207], v[220:223], v[128:143]
  ds_read_b64_tr_b16 v[172:173], v4 offset:28672
  ds_read_b64_tr_b16 v[174:175], v4 offset:29696
  ds_read_b128 v[188:191], v92 offset:21504
  s_barrier
  s_waitcnt lgkmcnt(9)
  v_mfma_f32_32x32x16_bf16 v[128:143], v[160:163], v[176:179], v[128:143]
  ds_read_b64_tr_b16 v[192:193], v4 offset:32768
  ds_read_b64_tr_b16 v[194:195], v4 offset:33792
  ds_read_b128 v[208:211], v92 offset:32768
  s_waitcnt lgkmcnt(9)
  v_mfma_f32_32x32x16_bf16 v[128:143], v[164:167], v[180:183], v[128:143]
  ds_read_b64_tr_b16 v[196:197], v4 offset:36864
  ds_read_b64_tr_b16 v[198:199], v4 offset:37888
  ds_read_b128 v[212:215], v92 offset:33792
  s_waitcnt lgkmcnt(9)
  v_mfma_f32_32x32x16_bf16 v[128:143], v[168:171], v[184:187], v[128:143]
  ds_read_b64_tr_b16 v[200:201], v4 offset:40960
  ds_read_b64_tr_b16 v[202:203], v4 offset:41984
  ds_read_b128 v[216:219], v92 offset:36864
  s_waitcnt lgkmcnt(9)
  v_mfma_f32_32x32x16_bf16 v[128:143], v[172:175], v[188:191], v[128:143]
  ds_read_b64_tr_b16 v[204:205], v4 offset:45056
  ds_read_b64_tr_b16 v[206:207], v4 offset:46080
  ds_read_b128 v[220:223], v92 offset:37888
  s_barrier
  s_waitcnt lgkmcnt(9)
  v_mfma_f32_32x32x16_bf16 v[128:143], v[192:195], v[208:211], v[128:143]
  ds_read_b64_tr_b16 v[160:161], v5 offset:32768
  ds_read_b64_tr_b16 v[162:163], v5 offset:33792
  ds_read_b128 v[176:179], v93 offset:32768
  s_waitcnt lgkmcnt(9)
  v_mfma_f32_32x32x16_bf16 v[128:143], v[196:199], v[212:215], v[128:143]
  ds_read_b64_tr_b16 v[164:165], v5 offset:36864
  ds_read_b64_tr_b16 v[166:167], v5 offset:37888
  ds_read_b128 v[180:183], v93 offset:33792
  s_waitcnt lgkmcnt(9)
  v_mfma_f32_32x32x16_bf16 v[128:143], v[200:203], v[216:219], v[128:143]
  ds_read_b64_tr_b16 v[168:169], v5 offset:40960
  ds_read_b64_tr_b16 v[170:171], v5 offset:41984
  ds_read_b128 v[184:187], v93 offset:36864
  s_waitcnt lgkmcnt(9)
  v_mfma_f32_32x32x16_bf16 v[128:143], v[204:207], v[220:223], v[128:143]
  ds_read_b64_tr_b16 v[172:173], v5 offset:45056
  ds_read_b64_tr_b16 v[174:175], v5 offset:46080
  ds_read_b128 v[188:191], v93 offset:37888
  s_barrier
  s_waitcnt lgkmcnt(9)
  v_mfma_f32_32x32x16_bf16 v[128:143], v[160:163], v[176:179], v[128:143]
  ds_read_b64_tr_b16 v[192:193], v6 offset:0
  ds_read_b64_tr_b16 v[194:195], v6 offset:1024
  ds_read_b128 v[208:211], v94 offset:0
  s_waitcnt lgkmcnt(9)
  v_mfma_f32_32x32x16_bf16 v[128:143], v[164:167], v[180:183], v[128:143]
  ds_read_b64_tr_b16 v[196:197], v6 offset:4096
  ds_read_b64_tr_b16 v[198:199], v6 offset:5120
  ds_read_b128 v[212:215], v94 offset:1024
  s_waitcnt lgkmcnt(9)
  v_mfma_f32_32x32x16_bf16 v[128:143], v[168:171], v[184:187], v[128:143]
  ds_read_b64_tr_b16 v[200:201], v6 offset:8192
  ds_read_b64_tr_b16 v[202:203], v6 offset:9216
  ds_read_b128 v[216:219], v94 offset:4096
  s_waitcnt lgkmcnt(9)
  v_mfma_f32_32x32x16_bf16 v[128:143], v[172:175], v[188:191], v[128:143]
  ds_read_b64_tr_b16 v[204:205], v6 offset:12288
  ds_read_b64_tr_b16 v[206:207], v6 offset:13312
  ds_read_b128 v[220:223], v94 offset:5120
  s_barrier
  s_waitcnt lgkmcnt(9)
  v_mfma_f32_32x32x16_bf16 v[128:143], v[192:195], v[208:211], v[128:143]
  ds_read_b64_tr_b16 v[160:161], v5 offset:49152
  ds_read_b64_tr_b16 v[162:163], v5 offset:50176
  ds_read_b128 v[176:179], v93 offset:49152
  s_waitcnt lgkmcnt(9)
  v_mfma_f32_32x32x16_bf16 v[128:143], v[196:199], v[212:215], v[128:143]
  ds_read_b64_tr_b16 v[164:165], v5 offset:53248
  ds_read_b64_tr_b16 v[166:167], v5 offset:54272
  ds_read_b128 v[180:183], v93 offset:50176
  s_waitcnt lgkmcnt(9)
  v_mfma_f32_32x32x16_bf16 v[128:143], v[200:203], v[216:219], v[128:143]
  ds_read_b64_tr_b16 v[168:169], v5 offset:57344
  ds_read_b64_tr_b16 v[170:171], v5 offset:58368
  ds_read_b128 v[184:187], v93 offset:53248
  s_waitcnt lgkmcnt(9)
  v_mfma_f32_32x32x16_bf16 v[128:143], v[204:207], v[220:223], v[128:143]
  ds_read_b64_tr_b16 v[172:173], v5 offset:61440
  ds_read_b64_tr_b16 v[174:175], v5 offset:62464
  ds_read_b128 v[188:191], v93 offset:54272
  s_barrier
  s_waitcnt lgkmcnt(9)
  v_mfma_f32_32x32x16_bf16 v[128:143], v[160:163], v[176:179], v[128:143]
  ds_read_b128 v[192:195], v80 offset:49152
  ds_read_b64_tr_b16 v[208:209], v7 offset:49152
  ds_read_b64_tr_b16 v[210:211], v7 offset:49408
  s_waitcnt lgkmcnt(9)
  v_mfma_f32_32x32x16_bf16 v[128:143], v[164:167], v[180:183], v[128:143]
  ds_read_b128 v[196:199], v81 offset:49152
  ds_read_b64_tr_b16 v[212:213], v7 offset:50176
  ds_read_b64_tr_b16 v[214:215], v7 offset:50432
  s_waitcnt lgkmcnt(9)
  v_mfma_f32_32x32x16_bf16 v[128:143], v[168:171], v[184:187], v[128:143]
  ds_read_b128 v[200:203], v82 offset:49152
  ds_read_b64_tr_b16 v[216:217], v7 offset:53248
  ds_read_b64_tr_b16 v[218:219], v7 offset:53504
  s_waitcnt lgkmcnt(9)
  v_mfma_f32_32x32x16_bf16 v[128:143], v[172:175], v[188:191], v[128:143]
  ds_read_b128 v[204:207], v83 offset:49152
  ds_read_b64_tr_b16 v[220:221], v7 offset:54272
  ds_read_b64_tr_b16 v[222:223], v7 offset:54528
  s_barrier
  s_waitcnt lgkmcnt(9)
  v_mfma_f32_32x32x16_bf16 v[144:159], v[192:195], v[208:211], v[144:159]
  ds_read_b128 v[160:163], v84 offset:0
  ds_read_b64_tr_b16 v[176:177], v8 offset:0
  ds_read_b64_tr_b16 v[178:179], v8 offset:256
  s_waitcnt lgkmcnt(9)
  v_mfma_f32_32x32x16_bf16 v[144:159], v[196:199], v[212:215], v[144:159]
  ds_read_b128 v[164:167], v85 offset:0
  ds_read_b64_tr_b16 v[180:181], v8 offset:1024
  ds_read_b64_tr_b16 v[182:183], v8 offset:1280
  s_waitcnt lgkmcnt(9)
  v_mfma_f32_32x32x16_bf16 v[144:159], v[200:203], v[216:219], v[144:159]
  ds_read_b128 v[168:171], v86 offset:0
  ds_read_b64_tr_b16 v[184:185], v8 offset:4096
  ds_read_b64_tr_b16 v[186:187], v8 offset:4352
  s_waitcnt lgkmcnt(9)
  v_mfma_f32_32x32x16_bf16 v[144:159], v[204:207], v[220:223], v[144:159]
  ds_read_b128 v[172:175], v87 offset:0
  ds_read_b64_tr_b16 v[188:189], v8 offset:5120
  ds_read_b64_tr_b16 v[190:191], v8 offset:5376
  s_barrier
  s_waitcnt lgkmcnt(9)
  v_mfma_f32_32x32x16_bf16 v[144:159], v[160:163], v[176:179], v[144:159]
  ds_read_b128 v[192:195], v80 offset:0
  ds_read_b64_tr_b16 v[208:209], v7 offset:0
  ds_read_b64_tr_b16 v[210:211], v7 offset:256
  v_mul_f32 v64, v128, v69
  v_exp_f32 v64, v64
  v_mul_f32 v128, v128, v68
  v_mul_f32 v66, v129, v69
  v_exp_f32 v66, v66
  v_mul_f32 v129, v129, v68
  s_waitcnt lgkmcnt(9)
  v_mfma_f32_32x32x16_bf16 v[144:159], v[164:167], v[180:183], v[144:159]
  ds_read_b128 v[196:199], v81 offset:0
  ds_read_b64_tr_b16 v[212:213], v7 offset:1024
  ds_read_b64_tr_b16 v[214:215], v7 offset:1280
  v_add_f32 v64, 1.0, v64
  v_rcp_f32 v64, v64
  s_nop 0
  v_mul_f32 v128, v128, v64
  v_add_f32 v66, 1.0, v66
  v_rcp_f32 v66, v66
  s_nop 0
  v_mul_f32 v129, v129, v66
  s_waitcnt lgkmcnt(9)
  v_mfma_f32_32x32x16_bf16 v[144:159], v[168:171], v[184:187], v[144:159]
  ds_read_b128 v[200:203], v82 offset:0
  ds_read_b64_tr_b16 v[216:217], v7 offset:4096
  ds_read_b64_tr_b16 v[218:219], v7 offset:4352
  v_mul_f32 v64, v130, v69
  v_exp_f32 v64, v64
  v_mul_f32 v130, v130, v68
  v_mul_f32 v66, v131, v69
  v_exp_f32 v66, v66
  v_mul_f32 v131, v131, v68
  s_waitcnt lgkmcnt(9)
  v_mfma_f32_32x32x16_bf16 v[144:159], v[172:175], v[188:191], v[144:159]
  ds_read_b128 v[204:207], v83 offset:0
  ds_read_b64_tr_b16 v[220:221], v7 offset:5120
  ds_read_b64_tr_b16 v[222:223], v7 offset:5376
  v_add_f32 v64, 1.0, v64
  v_rcp_f32 v64, v64
  s_nop 0
  v_mul_f32 v130, v130, v64
  v_add_f32 v66, 1.0, v66
  v_rcp_f32 v66, v66
  s_nop 0
  v_mul_f32 v131, v131, v66
  s_barrier
  s_waitcnt lgkmcnt(9)
  v_mfma_f32_32x32x16_bf16 v[144:159], v[192:195], v[208:211], v[144:159]
  ds_read_b128 v[160:163], v84 offset:16384
  ds_read_b64_tr_b16 v[176:177], v8 offset:16384
  ds_read_b64_tr_b16 v[178:179], v8 offset:16640
  v_mul_f32 v64, v132, v69
  v_exp_f32 v64, v64
  v_mul_f32 v132, v132, v68
  v_mul_f32 v66, v133, v69
  v_exp_f32 v66, v66
  v_mul_f32 v133, v133, v68
  s_waitcnt lgkmcnt(9)
  v_mfma_f32_32x32x16_bf16 v[144:159], v[196:199], v[212:215], v[144:159]
  ds_read_b128 v[164:167], v85 offset:16384
  ds_read_b64_tr_b16 v[180:181], v8 offset:17408
  ds_read_b64_tr_b16 v[182:183], v8 offset:17664
  v_add_f32 v64, 1.0, v64
  v_rcp_f32 v64, v64
  s_nop 0
  v_mul_f32 v132, v132, v64
  v_add_f32 v66, 1.0, v66
  v_rcp_f32 v66, v66
  s_nop 0
  v_mul_f32 v133, v133, v66
  s_waitcnt lgkmcnt(9)
  v_mfma_f32_32x32x16_bf16 v[144:159], v[200:203], v[216:219], v[144:159]
  ds_read_b128 v[168:171], v86 offset:16384
  ds_read_b64_tr_b16 v[184:185], v8 offset:20480
  ds_read_b64_tr_b16 v[186:187], v8 offset:20736
  v_mul_f32 v64, v134, v69
  v_exp_f32 v64, v64
  v_mul_f32 v134, v134, v68
  v_mul_f32 v66, v135, v69
  v_exp_f32 v66, v66
  v_mul_f32 v135, v135, v68
  s_waitcnt lgkmcnt(9)
  v_mfma_f32_32x32x16_bf16 v[144:159], v[204:207], v[220:223], v[144:159]
  ds_read_b128 v[172:175], v87 offset:16384
  ds_read_b64_tr_b16 v[188:189], v8 offset:21504
  ds_read_b64_tr_b16 v[190:191], v8 offset:21760
  v_add_f32 v64, 1.0, v64
  v_rcp_f32 v64, v64
  s_nop 0
  v_mul_f32 v134, v134, v64
  v_add_f32 v66, 1.0, v66
  v_rcp_f32 v66, v66
  s_nop 0
  v_mul_f32 v135, v135, v66
  s_barrier
  s_waitcnt lgkmcnt(9)
  v_mfma_f32_32x32x16_bf16 v[144:159], v[160:163], v[176:179], v[144:159]
  ds_read_b128 v[192:195], v80 offset:16384
  ds_read_b64_tr_b16 v[208:209], v7 offset:16384
  ds_read_b64_tr_b16 v[210:211], v7 offset:16640
  v_mul_f32 v64, v136, v69
  v_exp_f32 v64, v64
  v_mul_f32 v136, v136, v68
  v_mul_f32 v66, v137, v69
  v_exp_f32 v66, v66
  v_mul_f32 v137, v137, v68
  s_waitcnt lgkmcnt(9)
  v_mfma_f32_32x32x16_bf16 v[144:159], v[164:167], v[180:183], v[144:159]
  ds_read_b128 v[196:199], v81 offset:16384
  ds_read_b64_tr_b16 v[212:213], v7 offset:17408
  ds_read_b64_tr_b16 v[214:215], v7 offset:17664
  v_add_f32 v64, 1.0, v64
  v_rcp_f32 v64, v64
  s_nop 0
  v_mul_f32 v136, v136, v64
  v_add_f32 v66, 1.0, v66
  v_rcp_f32 v66, v66
  s_nop 0
  v_mul_f32 v137, v137, v66
  s_waitcnt lgkmcnt(9)
  v_mfma_f32_32x32x16_bf16 v[144:159], v[168:171], v[184:187], v[144:159]
  ds_read_b128 v[200:203], v82 offset:16384
  ds_read_b64_tr_b16 v[216:217], v7 offset:20480
  ds_read_b64_tr_b16 v[218:219], v7 offset:20736
  v_mul_f32 v64, v138, v69
  v_exp_f32 v64, v64
  v_mul_f32 v138, v138, v68
  v_mul_f32 v66, v139, v69
  v_exp_f32 v66, v66
  v_mul_f32 v139, v139, v68
  s_waitcnt lgkmcnt(9)
  v_mfma_f32_32x32x16_bf16 v[144:159], v[172:175], v[188:191], v[144:159]
  ds_read_b128 v[204:207], v83 offset:16384
  ds_read_b64_tr_b16 v[220:221], v7 offset:21504
  ds_read_b64_tr_b16 v[222:223], v7 offset:21760
  v_add_f32 v64, 1.0, v64
  v_rcp_f32 v64, v64
  s_nop 0
  v_mul_f32 v138, v138, v64
  v_add_f32 v66, 1.0, v66
  v_rcp_f32 v66, v66
  s_nop 0
  v_mul_f32 v139, v139, v66
  s_waitcnt lgkmcnt(9)
  v_mfma_f32_32x32x16_bf16 v[144:159], v[192:195], v[208:211], v[144:159]
  v_mul_f32 v64, v140, v69
  v_exp_f32 v64, v64
  v_mul_f32 v140, v140, v68
  v_mul_f32 v66, v141, v69
  v_exp_f32 v66, v66
  v_mul_f32 v141, v141, v68
  s_waitcnt lgkmcnt(6)
  v_mfma_f32_32x32x16_bf16 v[144:159], v[196:199], v[212:215], v[144:159]
  v_add_f32 v64, 1.0, v64
  v_rcp_f32 v64, v64
  s_nop 0
  v_mul_f32 v140, v140, v64
  v_add_f32 v66, 1.0, v66
  v_rcp_f32 v66, v66
  s_nop 0
  v_mul_f32 v141, v141, v66
  s_waitcnt lgkmcnt(3)
  v_mfma_f32_32x32x16_bf16 v[144:159], v[200:203], v[216:219], v[144:159]
  v_mul_f32 v64, v142, v69
  v_exp_f32 v64, v64
  v_mul_f32 v142, v142, v68
  v_mul_f32 v66, v143, v69
  v_exp_f32 v66, v66
  v_mul_f32 v143, v143, v68
  s_waitcnt lgkmcnt(0)
  v_mfma_f32_32x32x16_bf16 v[144:159], v[204:207], v[220:223], v[144:159]
  v_add_f32 v64, 1.0, v64
  v_rcp_f32 v64, v64
  s_nop 0
  v_mul_f32 v142, v142, v64
  v_add_f32 v66, 1.0, v66
  v_rcp_f32 v66, v66
  s_nop 0
  v_mul_f32 v143, v143, v66
  s_nop 3
  v_add_f32 v48, v144, v48
  v_add_f32 v49, v145, v49
  v_add_f32 v50, v146, v50
  v_add_f32 v51, v147, v51
  v_add_f32 v52, v148, v52
  v_add_f32 v53, v149, v53
  v_add_f32 v54, v150, v54
  v_add_f32 v55, v151, v55
  v_add_f32 v56, v152, v56
  v_add_f32 v57, v153, v57
  v_add_f32 v58, v154, v58
  v_add_f32 v59, v155, v59
  v_add_f32 v60, v156, v60
  v_add_f32 v61, v157, v61
  v_add_f32 v62, v158, v62
  v_add_f32 v63, v159, v63
  v_fma_f32 v32, v48, v128, v32
  v_fma_f32 v33, v49, v129, v33
  v_fma_f32 v34, v50, v130, v34
  v_fma_f32 v35, v51, v131, v35
  ds_write_b128 v100, v[32:35]
  v_fma_f32 v36, v52, v132, v36
  v_fma_f32 v37, v53, v133, v37
  v_fma_f32 v38, v54, v134, v38
  v_fma_f32 v39, v55, v135, v39
  ds_write_b128 v101, v[36:39]
  v_fma_f32 v40, v56, v136, v40
  v_fma_f32 v41, v57, v137, v41
  v_fma_f32 v42, v58, v138, v42
  v_fma_f32 v43, v59, v139, v43
  ds_write_b128 v102, v[40:43]
  v_fma_f32 v44, v60, v140, v44
  v_fma_f32 v45, v61, v141, v45
  v_fma_f32 v46, v62, v142, v46
  v_fma_f32 v47, v63, v143, v47
  ds_write_b128 v103, v[44:47]
  ds_read_b128 v[48:51], v104 offset:0
  ds_read_b128 v[52:55], v104 offset:1024
  ds_read_b128 v[56:59], v104 offset:2048
  ds_read_b128 v[60:63], v104 offset:3072
  s_mov_b32 s70, 8192
  s_mov_b32 s71, 16384
  s_mov_b32 s72, 24576
  s_waitcnt lgkmcnt(3)
  buffer_store_dwordx4 v[48:51], v105, s[24:27], 0 offen sc1 nt
  s_waitcnt lgkmcnt(2)
  buffer_store_dwordx4 v[52:55], v105, s[24:27], s70 offen sc1 nt
  s_waitcnt lgkmcnt(1)
  buffer_store_dwordx4 v[56:59], v105, s[24:27], s71 offen sc1 nt
  s_waitcnt lgkmcnt(0)
  buffer_store_dwordx4 v[60:63], v105, s[24:27], s72 offen sc1 nt
  s_endpgm
L_bl0_s:
  s_mov_b32 s86, 0
L_bl0_l:
  ds_read_b32 v18, v2 offset:1024
  s_waitcnt lgkmcnt(0)
  v_cmp_gt_u32 vcc, 1, v18
  s_cbranch_vccz L_bl0_k
  s_add_u32 s86, s86, 1
  s_cmp_lt_u32 s86, 200000
  s_cbranch_scc1 L_bl0_l
  s_branch L_bl0_k
L_bl1_s:
  s_mov_b32 s86, 0
L_bl1_l:
  ds_read_b32 v18, v2 offset:1024
  s_waitcnt lgkmcnt(0)
  v_cmp_gt_u32 vcc, 2, v18
  s_cbranch_vccz L_bl1_k
  s_add_u32 s86, s86, 1
  s_cmp_lt_u32 s86, 200000
  s_cbranch_scc1 L_bl1_l
  s_branch L_bl1_k
L_bl2_s:
  s_mov_b32 s86, 0
L_bl2_l:
  ds_read_b32 v18, v2 offset:1024
  s_waitcnt lgkmcnt(0)
  v_cmp_gt_u32 vcc, 3, v18
  s_cbranch_vccz L_bl2_k
  s_add_u32 s86, s86, 1
  s_cmp_lt_u32 s86, 200000
  s_cbranch_scc1 L_bl2_l
  s_branch L_bl2_k
L_bl3_s:
  s_mov_b32 s86, 0
L_bl3_l:
  ds_read_b32 v18, v2 offset:1024
  s_waitcnt lgkmcnt(0)
  v_cmp_gt_u32 vcc, 4, v18
  s_cbranch_vccz L_bl3_k
  s_add_u32 s86, s86, 1
  s_cmp_lt_u32 s86, 200000
  s_cbranch_scc1 L_bl3_l
  s_branch L_bl3_k
L_bl4_s:
  s_mov_b32 s86, 0
L_bl4_l:
  ds_read_b32 v18, v2 offset:1024
  s_waitcnt lgkmcnt(0)
  v_cmp_gt_u32 vcc, 5, v18
  s_cbranch_vccz L_bl4_k
  s_add_u32 s86, s86, 1
  s_cmp_lt_u32 s86, 200000
  s_cbranch_scc1 L_bl4_l
  s_branch L_bl4_k
L_bl5_s:
  s_mov_b32 s86, 0
L_bl5_l:
  ds_read_b32 v18, v2 offset:1024
  s_waitcnt lgkmcnt(0)
  v_cmp_gt_u32 vcc, 6, v18
  s_cbranch_vccz L_bl5_k
  s_add_u32 s86, s86, 1
  s_cmp_lt_u32 s86, 200000
  s_cbranch_scc1 L_bl5_l
  s_branch L_bl5_k
L_bl6_s:
  s_mov_b32 s86, 0
L_bl6_l:
  ds_read_b32 v18, v2 offset:1024
  s_waitcnt lgkmcnt(0)
  v_cmp_gt_u32 vcc, 7, v18
  s_cbranch_vccz L_bl6_k
  s_add_u32 s86, s86, 1
  s_cmp_lt_u32 s86, 200000
  s_cbranch_scc1 L_bl6_l
  s_branch L_bl6_k
L_bl7_s:
  s_mov_b32 s86, 0
L_bl7_l:
  ds_read_b32 v18, v2 offset:1024
  s_waitcnt lgkmcnt(0)
  v_cmp_gt_u32 vcc, 8, v18
  s_cbranch_vccz L_bl7_k
  s_add_u32 s86, s86, 1
  s_cmp_lt_u32 s86, 200000
  s_cbranch_scc1 L_bl7_l
  s_branch L_bl7_k
L_bcs_s:
  s_mov_b32 s86, 0
L_bcs_l:
  ds_read_b32 v18, v2 offset:0
  s_waitcnt lgkmcnt(0)
  v_cmp_gt_u32 vcc, 2, v18
  s_cbranch_vccz L_bcs_k
  s_add_u32 s86, s86, 1
  s_cmp_lt_u32 s86, 200000
  s_cbranch_scc1 L_bcs_l
  s_branch L_bcs_k
L_br0_s:
  s_mov_b32 s86, 0
L_br0_l:
  ds_read_b32 v18, v2 offset:1024
  s_waitcnt lgkmcnt(0)
  v_cmp_gt_u32 vcc, 9, v18
  s_cbranch_vccz L_br0_k
  s_add_u32 s86, s86, 1
  s_cmp_lt_u32 s86, 200000
  s_cbranch_scc1 L_br0_l
  s_branch L_br0_k
L_br6_s:
  s_mov_b32 s86, 0
L_br6_l:
  ds_read_b32 v18, v2 offset:1024
  s_waitcnt lgkmcnt(0)
  v_cmp_gt_u32 vcc, 10, v18
  s_cbranch_vccz L_br6_k
  s_add_u32 s86, s86, 1
  s_cmp_lt_u32 s86, 200000
  s_cbranch_scc1 L_br6_l
  s_branch L_br6_k
L_fb1_s:
  s_mov_b32 s86, 0
L_fb1_l:
  s_sleep 8
  buffer_load_dword v25, v23, s[8:11], s75 offen sc1
  s_waitcnt vmcnt(0)
  v_cmp_ne_u32 vcc, s66, v25
  s_and_b64 vcc, vcc, s[94:95]
  s_cbranch_vccz L_fb1_k
  s_add_u32 s86, s86, 1
  s_cmp_lt_u32 s86, 4000
  s_cbranch_scc1 L_fb1_l
  s_branch L_fb1_k
L_fb2_s:
  s_mov_b32 s86, 0
L_fb2_l:
  s_sleep 8
  buffer_load_dword v25, v23, s[8:11], s75 offen sc1
  s_waitcnt vmcnt(0)
  v_cmp_ne_u32 vcc, s66, v25
  s_and_b64 vcc, vcc, s[96:97]
  s_cbranch_vccz L_fb2_k
  s_add_u32 s86, s86, 1
  s_cmp_lt_u32 s86, 4000
  s_cbranch_scc1 L_fb2_l
  s_branch L_fb2_k
L_A:
  v_and_b32 v14, 31, v1
  v_lshrrev_b32 v15, 5, v1
  s_lshl_b32 s69, s64, 6
  v_lshlrev_b32 v28, 1, v14
  s_waitcnt lgkmcnt(0)
  s_load_dword s87, s[60:61], 0
  s_mov_b32 s4, s34
  s_mov_b32 s5, s35
  s_mov_b32 s6, 0x400
  s_mov_b32 s7, 0x00020000
  s_mov_b32 s12, s36
  s_mov_b32 s13, s37
  s_mov_b32 s14, 0x400
  s_mov_b32 s15, 0x00020000
  s_mov_b32 s16, s46
  s_mov_b32 s17, s47
  s_mov_b32 s18, 0x400
  s_mov_b32 s19, 0x00020000
  buffer_load_ushort v29, v28, s[4:7], s69 offen
  buffer_load_ushort v30, v28, s[12:15], s69 offen
  buffer_load_ushort v31, v28, s[16:19], s69 offen
  s_mov_b32 s8, s60
  s_mov_b32 s9, s61
  s_mov_b32 s10, 0x10000000
  s_mov_b32 s11, 0x00020000
  s_cmp_eq_u32 s62, 0
  s_cbranch_scc0 L_A_nopf
  s_getpc_b64 s[20:21]
L_pc:
  s_sub_u32 s20, s20, L_pc-recurrent_scan__ssm_conv_s5__glu_gated_swiglu__prompt_kernel
  s_subb_u32 s21, s21, 0
  s_lshr_b32 s70, s2, 3
  s_lshl_b32 s70, s70, 11
  v_and_b32 v32, 15, v1
  v_lshlrev_b32 v32, 7, v32
  v_add_u32 v32, s70, v32
  s_mov_b32 s71, L_end-recurrent_scan__ssm_conv_s5__glu_gated_swiglu__prompt_kernel-4
  v_min_u32 v32, s71, v32
  global_load_dword v255, v32, s[20:21]
L_A_nopf:
  v_bfe_u32 v32, v1, 1, 3
  v_xor_b32 v32, v32, v15
  v_lshlrev_b32 v32, 4, v32
  v_lshl_add_u32 v32, v14, 7, v32
  s_lshl_b32 s83, s62, 12
  v_add_u32 v34, s83, v32
  v_add_u32 v35, 81920, v32
  s_add_u32 s69, s62, 0
  s_and_b32 s69, s69, 3
  s_lshl_b32 s69, s69, 5
  v_xor_b32 v4, s69, v34
  v_xor_b32 v8, s69, v35
  s_add_u32 s69, s62, 1
  s_and_b32 s69, s69, 3
  s_lshl_b32 s69, s69, 5
  v_xor_b32 v5, s69, v34
  v_xor_b32 v9, s69, v35
  s_add_u32 s69, s62, 2
  s_and_b32 s69, s69, 3
  s_lshl_b32 s69, s69, 5
  v_xor_b32 v6, s69, v34
  v_xor_b32 v10, s69, v35
  s_add_u32 s69, s62, 3
  s_and_b32 s69, s69, 3
  s_lshl_b32 s69, s69, 5
  v_xor_b32 v7, s69, v34
  v_xor_b32 v11, s69, v35
  v_lshlrev_b32 v34, 2, v1
  v_and_b32 v35, 3, v1
  v_lshl_add_u32 v13, v35, 8, v34
  v_add_u32 v13, 147456, v13
  s_lshl_b32 s69, s62, 8
  s_add_u32 s69, s69, 147456
  v_add_u32 v12, s69, v34
  v_mov_b32 v34, 0
  ds_write_b32 v12, v34
  v_mov_b32 v192, 0x3f803f80
  v_mov_b32 v193, 0x3f803f80
  v_mov_b32 v194, 0x3f803f80
  v_mov_b32 v195, 0x3f803f80
  v_bfe_u32 v33, v1, 4, 1
  v_bfe_u32 v34, v1, 2, 2
  v_and_b32 v35, 3, v1
  v_lshl_add_u32 v36, v15, 3, v34
  v_mul_u32_u24 v37, 96, v36
  v_mul_u32_u24 v38, 6272, v33
  v_add_u32 v37, v37, v38
  v_lshl_add_u32 v37, v35, 3, v37
  s_lshr_b32 s70, s63, 3
  s_min_u32 s71, s62, 2
  s_lshl_b32 s71, s71, 5
  s_mul_i32 s72, s70, 3072
  s_add_u32 s72, s72, s71
  s_add_u32 s72, s72, 131072
  v_add_u32 v249, s72, v37
  v_xor_b32 v36, v36, v33
  v_lshlrev_b32 v36, 7, v36
  v_lshl_add_u32 v36, v33, 13, v36
  v_xor_b32 v34, s62, v34
  v_lshl_add_u32 v36, v34, 5, v36
  v_lshl_add_u32 v36, v35, 3, v36
  s_lshl_b32 s72, s70, 12
  s_add_u32 s72, s72, 114688
  v_add_u32 v248, s72, v36
  s_mov_b32 s92, 0x3fb8aa3b
  s_mov_b32 s93, 0x32a57060
  s_mov_b32 s94, 0x3f317218
  s_mov_b32 s95, 0x3e22f983
  s_mov_b32 s96, 0x31dc9c88
  s_waitcnt vmcnt(0)
  v_lshlrev_b32 v29, 16, v29
  v_lshlrev_b32 v30, 16, v30
  v_lshlrev_b32 v31, 16, v31
  v_mul_f32 v33, s92, v31
  v_fma_f32 v34, v31, s92, -v33
  v_fma_f32 v34, v31, s93, v34
  v_exp_f32 v32, v33
  v_mul_f32 v34, s94, v34
  v_fma_f32 v32, v32, v34, v32
  v_cvt_pk_bf16_f32 v32, v32, v32
  v_and_b32 v31, 0xffff0000, v32
  v_mul_f32 v32, v31, v29
  v_mul_f32 v33, v31, v30
  v_mul_f32 v35, s92, v32
  v_fma_f32 v36, v32, s92, -v35
  v_fma_f32 v36, v32, s93, v36
  v_exp_f32 v34, v35
  v_mul_f32 v36, s94, v36
  v_fma_f32 v34, v34, v36, v34
  v_mul_f32 v35, s95, v33
  v_fma_f32 v36, v33, s95, -v35
  v_fma_f32 v36, v33, s96, v36
  v_rndne_f32 v37, v35
  v_sub_f32 v35, v35, v37
  v_add_f32 v35, v35, v36
  v_cos_f32 v36, v35
  v_sin_f32 v37, v35
  v_mul_f32 v16, v34, v36
  v_mul_f32 v17, v34, v37
  v_add_f32 v32, -1.0, v16
  v_mul_f32 v33, v29, v29
  v_fma_f32 v33, v30, v30, v33
  v_rcp_f32 v33, v33
  v_mul_f32 v34, v32, v29
  v_fma_f32 v34, v17, v30, v34
  v_mul_f32 v35, v17, v29
  v_fma_f32 v35, -v32, v30, v35
  v_add_f32 v33, v33, v33
  v_mul_f32 v26, v34, v33
  v_mul_f32 v27, v35, v33
  v_mul_f32 v36, v17, v17
  v_add_f32 v33, v16, v16
  v_fma_f32 v32, v16, v16, -v36
  v_mul_f32 v33, v33, v17
  v_mul_f32 v36, v33, v33
  v_add_f32 v35, v32, v32
  v_fma_f32 v34, v32, v32, -v36
  v_mul_f32 v35, v35, v33
  v_mul_f32 v36, v35, v35
  v_add_f32 v33, v34, v34
  v_fma_f32 v32, v34, v34, -v36
  v_mul_f32 v33, v33, v35
  v_mul_f32 v36, v33, v33
  v_add_f32 v19, v32, v32
  v_fma_f32 v18, v32, v32, -v36
  v_mul_f32 v19, v19, v33
  v_mul_f32 v36, v19, v19
  v_add_f32 v39, v18, v18
  v_fma_f32 v38, v18, v18, -v36
  v_mul_f32 v39, v39, v19
  v_mul_f32 v36, v39, v39
  v_add_f32 v41, v38, v38
  v_fma_f32 v40, v38, v38, -v36
  v_mul_f32 v41, v41, v39
  v_mul_f32 v36, v41, v41
  v_add_f32 v21, v40, v40
  v_fma_f32 v20, v40, v40, -v36
  v_mul_f32 v21, v21, v41
  v_mul_f32 v36, v21, v21
  v_add_f32 v23, v20, v20
  v_fma_f32 v22, v20, v20, -v36
  v_mul_f32 v23, v23, v21
  v_cmp_eq_u32 vcc, 1, v15
  s_nop 1
  v_cndmask_b32 v32, 1.0, v18, vcc
  v_cndmask_b32 v33, 0, v19, vcc
  s_bitcmp1_b32 s62, 0
  s_cselect_b64 vcc, -1, 0
  v_cndmask_b32 v38, 1.0, v38, vcc
  v_cndmask_b32 v39, 0, v39, vcc
  s_bitcmp1_b32 s62, 1
  s_cselect_b64 vcc, -1, 0
  v_cndmask_b32 v40, 1.0, v40, vcc
  v_cndmask_b32 v41, 0, v41, vcc
  v_mul_f32 v34, v32, v38
  v_mul_f32 v35, v32, v39
  v_fma_f32 v34, -v33, v39, v34
  v_fma_f32 v35, v33, v38, v35
  v_mul_f32 v24, v34, v40
  v_mul_f32 v25, v34, v41
  v_fma_f32 v24, -v35, v41, v24
  v_fma_f32 v25, v35, v40, v25
  s_waitcnt lgkmcnt(0)
  s_mul_i32 s66, s87, 0x9E3779B1
  s_add_u32 s66, s66, 0x7F4A7C15
  s_cmp_eq_u32 s66, 0
  s_cselect_b32 s66, 0x5bd1e995, s66
  s_barrier
  ds_read_b128 v[96:99], v4 offset:0
  ds_read_b128 v[128:131], v8 offset:0
  ds_read_b128 v[132:135], v8 offset:4096
  ds_read_b128 v[100:103], v5 offset:0
  ds_read_b128 v[136:139], v9 offset:0
  ds_read_b128 v[140:143], v9 offset:4096
  ds_read_b128 v[104:107], v6 offset:0
  ds_read_b128 v[144:147], v10 offset:0
  ds_read_b128 v[148:151], v10 offset:4096
  ds_read_b128 v[108:111], v7 offset:0
  ds_read_b128 v[152:155], v11 offset:0
  ds_read_b128 v[156:159], v11 offset:4096
  s_waitcnt lgkmcnt(0)
  s_barrier
  ds_read_b128 v[112:115], v4 offset:16384
  ds_read_b128 v[160:163], v8 offset:8192
  ds_read_b128 v[164:167], v8 offset:12288
  ds_read_b128 v[116:119], v5 offset:16384
  ds_read_b128 v[168:171], v9 offset:8192
  ds_read_b128 v[172:175], v9 offset:12288
  ds_read_b128 v[120:123], v6 offset:16384
  ds_read_b128 v[176:179], v10 offset:8192
  ds_read_b128 v[180:183], v10 offset:12288
  ds_read_b128 v[124:127], v7 offset:16384
  ds_read_b128 v[184:187], v11 offset:8192
  ds_read_b128 v[188:191], v11 offset:12288
  v_mfma_f32_32x32x16_bf16 v[48:63], v[96:99], v[128:131], 0
  v_mfma_f32_4x4x4_16b_bf16 v[80:83], v[192:193], v[128:129], 0
  v_mfma_f32_4x4x4_16b_bf16 v[84:87], v[192:193], v[130:131], 0
  v_mfma_f32_32x32x16_bf16 v[64:79], v[96:99], v[132:135], 0
  v_mfma_f32_4x4x4_16b_bf16 v[88:91], v[192:193], v[132:133], 0
  v_mfma_f32_4x4x4_16b_bf16 v[92:95], v[192:193], v[134:135], 0
  v_mfma_f32_32x32x16_bf16 v[48:63], v[100:103], v[136:139], v[48:63]
  v_mfma_f32_32x32x16_bf16 v[64:79], v[100:103], v[140:143], v[64:79]
  v_mfma_f32_32x32x16_bf16 v[48:63], v[104:107], v[144:147], v[48:63]
  v_mfma_f32_32x32x16_bf16 v[64:79], v[104:107], v[148:151], v[64:79]
  v_mfma_f32_32x32x16_bf16 v[48:63], v[108:111], v[152:155], v[48:63]
  v_mfma_f32_32x32x16_bf16 v[64:79], v[108:111], v[156:159], v[64:79]
  s_waitcnt lgkmcnt(0)
  s_barrier
  ds_read_b128 v[96:99], v4 offset:32768
  ds_read_b128 v[128:131], v8 offset:16384
  ds_read_b128 v[132:135], v8 offset:20480
  ds_read_b128 v[100:103], v5 offset:32768
  ds_read_b128 v[136:139], v9 offset:16384
  ds_read_b128 v[140:143], v9 offset:20480
  ds_read_b128 v[104:107], v6 offset:32768
  ds_read_b128 v[144:147], v10 offset:16384
  ds_read_b128 v[148:151], v10 offset:20480
  ds_read_b128 v[108:111], v7 offset:32768
  ds_read_b128 v[152:155], v11 offset:16384
  ds_read_b128 v[156:159], v11 offset:20480
  v_mfma_f32_32x32x16_bf16 v[48:63], v[112:115], v[160:163], v[48:63]
  v_mfma_f32_4x4x4_16b_bf16 v[80:83], v[192:193], v[160:161], v[80:83]
  v_mfma_f32_4x4x4_16b_bf16 v[84:87], v[192:193], v[162:163], v[84:87]
  v_mfma_f32_32x32x16_bf16 v[64:79], v[112:115], v[164:167], v[64:79]
  v_mfma_f32_4x4x4_16b_bf16 v[88:91], v[192:193], v[164:165], v[88:91]
  v_mfma_f32_4x4x4_16b_bf16 v[92:95], v[192:193], v[166:167], v[92:95]
  v_mfma_f32_32x32x16_bf16 v[48:63], v[116:119], v[168:171], v[48:63]
  v_mfma_f32_32x32x16_bf16 v[64:79], v[116:119], v[172:175], v[64:79]
  v_mfma_f32_32x32x16_bf16 v[48:63], v[120:123], v[176:179], v[48:63]
  v_mfma_f32_32x32x16_bf16 v[64:79], v[120:123], v[180:183], v[64:79]
  v_mfma_f32_32x32x16_bf16 v[48:63], v[124:127], v[184:187], v[48:63]
  v_mfma_f32_32x32x16_bf16 v[64:79], v[124:127], v[188:191], v[64:79]
  s_waitcnt lgkmcnt(0)
  s_barrier
  ds_read_b128 v[112:115], v4 offset:49152
  ds_read_b128 v[160:163], v8 offset:24576
  ds_read_b128 v[164:167], v8 offset:28672
  ds_read_b128 v[116:119], v5 offset:49152
  ds_read_b128 v[168:171], v9 offset:24576
  ds_read_b128 v[172:175], v9 offset:28672
  ds_read_b128 v[120:123], v6 offset:49152
  ds_read_b128 v[176:179], v10 offset:24576
  ds_read_b128 v[180:183], v10 offset:28672
  ds_read_b128 v[124:127], v7 offset:49152
  ds_read_b128 v[184:187], v11 offset:24576
  ds_read_b128 v[188:191], v11 offset:28672
  v_mfma_f32_32x32x16_bf16 v[48:63], v[96:99], v[128:131], v[48:63]
  v_mfma_f32_4x4x4_16b_bf16 v[80:83], v[192:193], v[128:129], v[80:83]
  v_mfma_f32_4x4x4_16b_bf16 v[84:87], v[192:193], v[130:131], v[84:87]
  v_mfma_f32_32x32x16_bf16 v[64:79], v[96:99], v[132:135], v[64:79]
  v_mfma_f32_4x4x4_16b_bf16 v[88:91], v[192:193], v[132:133], v[88:91]
  v_mfma_f32_4x4x4_16b_bf16 v[92:95], v[192:193], v[134:135], v[92:95]
  v_mfma_f32_32x32x16_bf16 v[48:63], v[100:103], v[136:139], v[48:63]
  v_mfma_f32_32x32x16_bf16 v[64:79], v[100:103], v[140:143], v[64:79]
  v_mfma_f32_32x32x16_bf16 v[48:63], v[104:107], v[144:147], v[48:63]
  v_mfma_f32_32x32x16_bf16 v[64:79], v[104:107], v[148:151], v[64:79]
  v_mfma_f32_32x32x16_bf16 v[48:63], v[108:111], v[152:155], v[48:63]
  v_mfma_f32_32x32x16_bf16 v[64:79], v[108:111], v[156:159], v[64:79]
  s_waitcnt lgkmcnt(0)
  s_barrier
  v_add_u32 v4, 65536, v4
  v_add_u32 v5, 65536, v5
  v_add_u32 v6, 65536, v6
  v_add_u32 v7, 65536, v7
  ds_read_b128 v[96:99], v4 offset:0
  ds_read_b128 v[128:131], v8 offset:0
  ds_read_b128 v[132:135], v8 offset:4096
  ds_read_b128 v[100:103], v5 offset:0
  ds_read_b128 v[136:139], v9 offset:0
  ds_read_b128 v[140:143], v9 offset:4096
  ds_read_b128 v[104:107], v6 offset:0
  ds_read_b128 v[144:147], v10 offset:0
  ds_read_b128 v[148:151], v10 offset:4096
  ds_read_b128 v[108:111], v7 offset:0
  ds_read_b128 v[152:155], v11 offset:0
  ds_read_b128 v[156:159], v11 offset:4096
  v_mfma_f32_32x32x16_bf16 v[48:63], v[112:115], v[160:163], v[48:63]
  v_mfma_f32_4x4x4_16b_bf16 v[80:83], v[192:193], v[160:161], v[80:83]
  v_mfma_f32_4x4x4_16b_bf16 v[84:87], v[192:193], v[162:163], v[84:87]
  v_mfma_f32_32x32x16_bf16 v[64:79], v[112:115], v[164:167], v[64:79]
  v_mfma_f32_4x4x4_16b_bf16 v[88:91], v[192:193], v[164:165], v[88:91]
  v_mfma_f32_4x4x4_16b_bf16 v[92:95], v[192:193], v[166:167], v[92:95]
  v_mfma_f32_32x32x16_bf16 v[48:63], v[116:119], v[168:171], v[48:63]
  v_mfma_f32_32x32x16_bf16 v[64:79], v[116:119], v[172:175], v[64:79]
  v_mfma_f32_32x32x16_bf16 v[48:63], v[120:123], v[176:179], v[48:63]
  v_mfma_f32_32x32x16_bf16 v[64:79], v[120:123], v[180:183], v[64:79]
  v_mfma_f32_32x32x16_bf16 v[48:63], v[124:127], v[184:187], v[48:63]
  v_mfma_f32_32x32x16_bf16 v[64:79], v[124:127], v[188:191], v[64:79]
  ds_read_b64_tr_b16 v[232:233], v248 offset:0
  ds_read_b64_tr_b16 v[234:235], v248 offset:512
  ds_read_b64_tr_b16 v[236:237], v248 offset:2048
  ds_read_b64_tr_b16 v[238:239], v248 offset:2560
  s_waitcnt lgkmcnt(0)
  v_mfma_f32_32x32x16_bf16 v[200:215], v[192:195], v[232:235], 0
  v_mfma_f32_32x32x16_bf16 v[200:215], v[192:195], v[236:239], v[200:215]
  s_waitcnt lgkmcnt(0)
  s_barrier
  v_add_u32 v4, 4294901760, v4
  v_add_u32 v5, 4294901760, v5
  v_add_u32 v6, 4294901760, v6
  v_add_u32 v7, 4294901760, v7
  ds_read_b128 v[112:115], v4 offset:0
  ds_read_b128 v[160:163], v8 offset:8192
  ds_read_b128 v[164:167], v8 offset:12288
  ds_read_b128 v[116:119], v5 offset:0
  ds_read_b128 v[168:171], v9 offset:8192
  ds_read_b128 v[172:175], v9 offset:12288
  ds_read_b128 v[120:123], v6 offset:0
  ds_read_b128 v[176:179], v10 offset:8192
  ds_read_b128 v[180:183], v10 offset:12288
  ds_read_b128 v[124:127], v7 offset:0
  ds_read_b128 v[184:187], v11 offset:8192
  ds_read_b128 v[188:191], v11 offset:12288
  v_mfma_f32_32x32x16_bf16 v[48:63], v[96:99], v[128:131], v[48:63]
  v_mfma_f32_4x4x4_16b_bf16 v[80:83], v[192:193], v[128:129], v[80:83]
  v_mfma_f32_4x4x4_16b_bf16 v[84:87], v[192:193], v[130:131], v[84:87]
  v_mfma_f32_32x32x16_bf16 v[64:79], v[96:99], v[132:135], v[64:79]
  v_mfma_f32_4x4x4_16b_bf16 v[88:91], v[192:193], v[132:133], v[88:91]
  v_mfma_f32_4x4x4_16b_bf16 v[92:95], v[192:193], v[134:135], v[92:95]
  v_mfma_f32_32x32x16_bf16 v[48:63], v[100:103], v[136:139], v[48:63]
  v_mfma_f32_32x32x16_bf16 v[64:79], v[100:103], v[140:143], v[64:79]
  v_mfma_f32_32x32x16_bf16 v[48:63], v[104:107], v[144:147], v[48:63]
  v_mfma_f32_32x32x16_bf16 v[64:79], v[104:107], v[148:151], v[64:79]
  v_mfma_f32_32x32x16_bf16 v[48:63], v[108:111], v[152:155], v[48:63]
  v_mfma_f32_32x32x16_bf16 v[64:79], v[108:111], v[156:159], v[64:79]
  ds_read_b64_tr_b16 v[240:241], v249 offset:0
  ds_read_b64_tr_b16 v[242:243], v249 offset:384
  ds_read_b64_tr_b16 v[244:245], v249 offset:1536
  ds_read_b64_tr_b16 v[246:247], v249 offset:1920
  s_waitcnt lgkmcnt(0)
  v_mfma_f32_32x32x16_bf16 v[216:231], v[192:195], v[240:243], 0
  v_mfma_f32_32x32x16_bf16 v[216:231], v[192:195], v[244:247], v[216:231]
  s_waitcnt lgkmcnt(0)
  s_barrier
  ds_read_b128 v[96:99], v4 offset:16384
  ds_read_b128 v[128:131], v8 offset:16384
  ds_read_b128 v[132:135], v8 offset:20480
  ds_read_b128 v[100:103], v5 offset:16384
  ds_read_b128 v[136:139], v9 offset:16384
  ds_read_b128 v[140:143], v9 offset:20480
  ds_read_b128 v[104:107], v6 offset:16384
  ds_read_b128 v[144:147], v10 offset:16384
  ds_read_b128 v[148:151], v10 offset:20480
  ds_read_b128 v[108:111], v7 offset:16384
  ds_read_b128 v[152:155], v11 offset:16384
  ds_read_b128 v[156:159], v11 offset:20480
  v_mfma_f32_32x32x16_bf16 v[48:63], v[112:115], v[160:163], v[48:63]
  v_mfma_f32_4x4x4_16b_bf16 v[80:83], v[192:193], v[160:161], v[80:83]
  v_mfma_f32_4x4x4_16b_bf16 v[84:87], v[192:193], v[162:163], v[84:87]
  v_mfma_f32_32x32x16_bf16 v[64:79], v[112:115], v[164:167], v[64:79]
  v_mfma_f32_4x4x4_16b_bf16 v[88:91], v[192:193], v[164:165], v[88:91]
  v_mfma_f32_4x4x4_16b_bf16 v[92:95], v[192:193], v[166:167], v[92:95]
  v_mfma_f32_32x32x16_bf16 v[48:63], v[116:119], v[168:171], v[48:63]
  v_mfma_f32_32x32x16_bf16 v[64:79], v[116:119], v[172:175], v[64:79]
  v_mfma_f32_32x32x16_bf16 v[48:63], v[120:123], v[176:179], v[48:63]
  v_mfma_f32_32x32x16_bf16 v[64:79], v[120:123], v[180:183], v[64:79]
  v_mfma_f32_32x32x16_bf16 v[48:63], v[124:127], v[184:187], v[48:63]
  v_mfma_f32_32x32x16_bf16 v[64:79], v[124:127], v[188:191], v[64:79]
  s_lshl_b32 s90, s64, 15
  s_lshl_b32 s69, s62, 9
  s_add_u32 s90, s90, s69
  s_add_u32 s90, s90, 131072
  s_lshl_b32 s69, s63, 11
  s_add_u32 s69, s69, s90
  v_lshlrev_b32 v28, 4, v1
  v_mov_b32 v35, s66
  v_mov_b32 v32, v200
  v_mov_b32 v33, v216
  v_mov_b32 v34, 0
  s_mov_b64 exec, s[84:85]
  buffer_store_dwordx4 v[32:35], v28, s[8:11], s69 offen sc1
  s_mov_b64 exec, -1
  s_waitcnt lgkmcnt(0)
  s_barrier
  ds_read_b128 v[112:115], v4 offset:32768
  ds_read_b128 v[160:163], v8 offset:24576
  ds_read_b128 v[164:167], v8 offset:28672
  ds_read_b128 v[116:119], v5 offset:32768
  ds_read_b128 v[168:171], v9 offset:24576
  ds_read_b128 v[172:175], v9 offset:28672
  ds_read_b128 v[120:123], v6 offset:32768
  ds_read_b128 v[176:179], v10 offset:24576
  ds_read_b128 v[180:183], v10 offset:28672
  ds_read_b128 v[124:127], v7 offset:32768
  ds_read_b128 v[184:187], v11 offset:24576
  ds_read_b128 v[188:191], v11 offset:28672
  v_mfma_f32_32x32x16_bf16 v[48:63], v[96:99], v[128:131], v[48:63]
  v_mfma_f32_4x4x4_16b_bf16 v[80:83], v[192:193], v[128:129], v[80:83]
  v_mfma_f32_4x4x4_16b_bf16 v[84:87], v[192:193], v[130:131], v[84:87]
  v_mfma_f32_32x32x16_bf16 v[64:79], v[96:99], v[132:135], v[64:79]
  v_mfma_f32_4x4x4_16b_bf16 v[88:91], v[192:193], v[132:133], v[88:91]
  v_mfma_f32_4x4x4_16b_bf16 v[92:95], v[192:193], v[134:135], v[92:95]
  v_mfma_f32_32x32x16_bf16 v[48:63], v[100:103], v[136:139], v[48:63]
  v_mfma_f32_32x32x16_bf16 v[64:79], v[100:103], v[140:143], v[64:79]
  v_mfma_f32_32x32x16_bf16 v[48:63], v[104:107], v[144:147], v[48:63]
  v_mfma_f32_32x32x16_bf16 v[64:79], v[104:107], v[148:151], v[64:79]
  v_mfma_f32_32x32x16_bf16 v[48:63], v[108:111], v[152:155], v[48:63]
  v_mfma_f32_32x32x16_bf16 v[64:79], v[108:111], v[156:159], v[64:79]
  s_waitcnt lgkmcnt(0)
  v_mfma_f32_32x32x16_bf16 v[48:63], v[112:115], v[160:163], v[48:63]
  v_mfma_f32_4x4x4_16b_bf16 v[80:83], v[192:193], v[160:161], v[80:83]
  v_mfma_f32_4x4x4_16b_bf16 v[84:87], v[192:193], v[162:163], v[84:87]
  v_mfma_f32_32x32x16_bf16 v[64:79], v[112:115], v[164:167], v[64:79]
  v_mfma_f32_4x4x4_16b_bf16 v[88:91], v[192:193], v[164:165], v[88:91]
  v_mfma_f32_4x4x4_16b_bf16 v[92:95], v[192:193], v[166:167], v[92:95]
  v_mfma_f32_32x32x16_bf16 v[48:63], v[116:119], v[168:171], v[48:63]
  v_mfma_f32_32x32x16_bf16 v[64:79], v[116:119], v[172:175], v[64:79]
  v_mfma_f32_32x32x16_bf16 v[48:63], v[120:123], v[176:179], v[48:63]
  v_mfma_f32_32x32x16_bf16 v[64:79], v[120:123], v[180:183], v[64:79]
  v_mfma_f32_32x32x16_bf16 v[48:63], v[124:127], v[184:187], v[48:63]
  v_mfma_f32_32x32x16_bf16 v[64:79], v[124:127], v[188:191], v[64:79]
  v_add_f32 v28, v80, v84
  v_add_f32 v29, v88, v92
  v_lshlrev_b32 v30, 4, v1
  s_lshl_b32 s69, s62, 2
  s_add_u32 s69, s69, 153600
  v_add_u32 v30, s69, v30
  v_permlane32_swap_b32 v28, v29
  v_add_f32 v28, v28, v29
  ds_write_b32 v30, v28
  v_lshlrev_b32 v44, 11, v15
  v_lshl_add_u32 v44, v14, 4, v44
  s_waitcnt lgkmcnt(0)
  s_barrier
  v_lshlrev_b32 v28, 4, v14
  v_add_u32 v28, 153600, v28
  s_lshl_b32 s69, s62, 7
  s_add_u32 s69, s69, 152576
  v_lshlrev_b32 v29, 6, v15
  v_add_u32 v29, s69, v29
  ds_read_b128 v[32:35], v28
  ds_read_b128 v[36:39], v28 offset:512
  ds_read_b128 v[96:99], v29 offset:0
  ds_read_b128 v[112:115], v29 offset:512
  ds_read_b128 v[100:103], v29 offset:16
  ds_read_b128 v[116:119], v29 offset:528
  ds_read_b128 v[104:107], v29 offset:32
  ds_read_b128 v[120:123], v29 offset:544
  ds_read_b128 v[108:111], v29 offset:48
  ds_read_b128 v[124:127], v29 offset:560
  s_add_u32 s69, s90, 0
  buffer_load_dwordx4 v[160:163], v44, s[8:11], s69 offen sc1
  s_add_u32 s69, s90, 4096
  buffer_load_dwordx4 v[164:167], v44, s[8:11], s69 offen sc1
  s_add_u32 s69, s90, 8192
  buffer_load_dwordx4 v[168:171], v44, s[8:11], s69 offen sc1
  s_add_u32 s69, s90, 12288
  buffer_load_dwordx4 v[172:175], v44, s[8:11], s69 offen sc1
  s_add_u32 s69, s90, 16384
  buffer_load_dwordx4 v[176:179], v44, s[8:11], s69 offen sc1
  s_add_u32 s69, s90, 20480
  buffer_load_dwordx4 v[180:183], v44, s[8:11], s69 offen sc1
  s_add_u32 s69, s90, 24576
  buffer_load_dwordx4 v[184:187], v44, s[8:11], s69 offen sc1
  s_add_u32 s69, s90, 28672
  buffer_load_dwordx4 v[188:191], v44, s[8:11], s69 offen sc1
  s_waitcnt lgkmcnt(8)
  v_add_f32 v30, v32, v33
  v_add_f32 v31, v36, v37
  v_add_f32 v34, v34, v35
  v_add_f32 v38, v38, v39
  v_add_f32 v30, v30, v34
  v_add_f32 v31, v31, v38
  s_waitcnt lgkmcnt(0)
  v_mul_f32 v32, v112, v30
  v_mul_f32 v33, v112, v31
  v_fma_f32 v48, v48, v96, -v32
  v_fma_f32 v64, v64, v96, -v33
  v_mul_f32 v32, v113, v30
  v_mul_f32 v33, v113, v31
  v_fma_f32 v49, v49, v97, -v32
  v_fma_f32 v65, v65, v97, -v33
  v_mul_f32 v32, v114, v30
  v_mul_f32 v33, v114, v31
  v_fma_f32 v50, v50, v98, -v32
  v_fma_f32 v66, v66, v98, -v33
  v_mul_f32 v32, v115, v30
  v_mul_f32 v33, v115, v31
  v_fma_f32 v51, v51, v99, -v32
  v_fma_f32 v67, v67, v99, -v33
  v_mul_f32 v32, v116, v30
  v_mul_f32 v33, v116, v31
  v_fma_f32 v52, v52, v100, -v32
  v_fma_f32 v68, v68, v100, -v33
  v_mul_f32 v32, v117, v30
  v_mul_f32 v33, v117, v31
  v_fma_f32 v53, v53, v101, -v32
  v_fma_f32 v69, v69, v101, -v33
  v_mul_f32 v32, v118, v30
  v_mul_f32 v33, v118, v31
  v_fma_f32 v54, v54, v102, -v32
  v_fma_f32 v70, v70, v102, -v33
  v_mul_f32 v32, v119, v30
  v_mul_f32 v33, v119, v31
  v_fma_f32 v55, v55, v103, -v32
  v_fma_f32 v71, v71, v103, -v33
  v_mul_f32 v32, v120, v30
  v_mul_f32 v33, v120, v31
  v_fma_f32 v56, v56, v104, -v32
  v_fma_f32 v72, v72, v104, -v33
  v_mul_f32 v32, v121, v30
  v_mul_f32 v33, v121, v31
  v_fma_f32 v57, v57, v105, -v32
  v_fma_f32 v73, v73, v105, -v33
  v_mul_f32 v32, v122, v30
  v_mul_f32 v33, v122, v31
  v_fma_f32 v58, v58, v106, -v32
  v_fma_f32 v74, v74, v106, -v33
  v_mul_f32 v32, v123, v30
  v_mul_f32 v33, v123, v31
  v_fma_f32 v59, v59, v107, -v32
  v_fma_f32 v75, v75, v107, -v33
  v_mul_f32 v32, v124, v30
  v_mul_f32 v33, v124, v31
  v_fma_f32 v60, v60, v108, -v32
  v_fma_f32 v76, v76, v108, -v33
  v_mul_f32 v32, v125, v30
  v_mul_f32 v33, v125, v31
  v_fma_f32 v61, v61, v109, -v32
  v_fma_f32 v77, v77, v109, -v33
  v_mul_f32 v32, v126, v30
  v_mul_f32 v33, v126, v31
  v_fma_f32 v62, v62, v110, -v32
  v_fma_f32 v78, v78, v110, -v33
  v_mul_f32 v32, v127, v30
  v_mul_f32 v33, v127, v31
  v_fma_f32 v63, v63, v111, -v32
  v_fma_f32 v79, v79, v111, -v33
  v_fma_f32 v30, v16, v48, v49
  v_fma_f32 v31, v16, v64, v65
  v_fma_f32 v30, -v17, v64, v30
  v_fma_f32 v31, v17, v48, v31
  v_fma_f32 v32, v16, v30, v50
  v_fma_f32 v33, v16, v31, v66
  v_fma_f32 v32, -v17, v31, v32
  v_fma_f32 v33, v17, v30, v33
  v_fma_f32 v30, v16, v32, v51
  v_fma_f32 v31, v16, v33, v67
  v_fma_f32 v30, -v17, v33, v30
  v_fma_f32 v31, v17, v32, v31
  v_fma_f32 v32, v16, v30, v52
  v_fma_f32 v33, v16, v31, v68
  v_fma_f32 v32, -v17, v31, v32
  v_fma_f32 v33, v17, v30, v33
  v_fma_f32 v30, v16, v32, v53
  v_fma_f32 v31, v16, v33, v69
  v_fma_f32 v30, -v17, v33, v30
  v_fma_f32 v31, v17, v32, v31
  v_fma_f32 v32, v16, v30, v54
  v_fma_f32 v33, v16, v31, v70
  v_fma_f32 v32, -v17, v31, v32
  v_fma_f32 v33, v17, v30, v33
  v_fma_f32 v30, v16, v32, v55
  v_fma_f32 v31, v16, v33, v71
  v_fma_f32 v30, -v17, v33, v30
  v_fma_f32 v31, v17, v32, v31
  v_fma_f32 v32, v16, v30, v56
  v_fma_f32 v33, v16, v31, v72
  v_fma_f32 v32, -v17, v31, v32
  v_fma_f32 v33, v17, v30, v33
  v_fma_f32 v30, v16, v32, v57
  v_fma_f32 v31, v16, v33, v73
  v_fma_f32 v30, -v17, v33, v30
  v_fma_f32 v31, v17, v32, v31
  v_fma_f32 v32, v16, v30, v58
  v_fma_f32 v33, v16, v31, v74
  v_fma_f32 v32, -v17, v31, v32
  v_fma_f32 v33, v17, v30, v33
  v_fma_f32 v30, v16, v32, v59
  v_fma_f32 v31, v16, v33, v75
  v_fma_f32 v30, -v17, v33, v30
  v_fma_f32 v31, v17, v32, v31
  v_fma_f32 v32, v16, v30, v60
  v_fma_f32 v33, v16, v31, v76
  v_fma_f32 v32, -v17, v31, v32
  v_fma_f32 v33, v17, v30, v33
  v_fma_f32 v30, v16, v32, v61
  v_fma_f32 v31, v16, v33, v77
  v_fma_f32 v30, -v17, v33, v30
  v_fma_f32 v31, v17, v32, v31
  v_fma_f32 v32, v16, v30, v62
  v_fma_f32 v33, v16, v31, v78
  v_fma_f32 v32, -v17, v31, v32
  v_fma_f32 v33, v17, v30, v33
  v_fma_f32 v30, v16, v32, v63
  v_fma_f32 v31, v16, v33, v79
  v_fma_f32 v30, -v17, v33, v30
  v_fma_f32 v31, v17, v32, v31
  s_lshl_b32 s69, s62, 9
  s_add_u32 s69, s69, 150528
  v_lshlrev_b32 v34, 3, v1
  v_add_u32 v34, s69, v34
  v_mov_b32 v36, 1
  ds_write_b64 v34, v[30:31]
  ds_write_b32 v12, v36
  v_lshlrev_b32 v37, 3, v14
  v_add_u32 v42, s69, v37
  v_add_u32 v37, 150528, v37
  ds_read_b32 v38, v13 offset:0
  s_waitcnt lgkmcnt(0)
  v_cmp_gt_u32 vcc, 1, v38
  s_cbranch_vccnz L_asg_s
L_asg_k:
  ds_read_b64 v[96:97], v37 offset:0
  ds_read_b64 v[98:99], v37 offset:256
  ds_read_b64 v[100:101], v37 offset:512
  ds_read_b64 v[102:103], v37 offset:768
  ds_read_b64 v[104:105], v37 offset:1024
  ds_read_b64 v[106:107], v37 offset:1280
  ds_read_b64 v[108:109], v42
  v_mov_b32 v38, 0
  v_mov_b32 v39, 0
  s_waitcnt lgkmcnt(0)
  s_cmp_le_u32 s62, 0
  s_cbranch_scc1 L_A_pdone
  v_fma_f32 v40, v18, v38, v96
  v_fma_f32 v41, v18, v39, v97
  v_fma_f32 v40, -v19, v39, v40
  v_fma_f32 v41, v19, v38, v41
  v_fma_f32 v38, v18, v40, v98
  v_fma_f32 v39, v18, v41, v99
  v_fma_f32 v38, -v19, v41, v38
  v_fma_f32 v39, v19, v40, v39
  s_cmp_le_u32 s62, 1
  s_cbranch_scc1 L_A_pdone
  v_fma_f32 v40, v18, v38, v100
  v_fma_f32 v41, v18, v39, v101
  v_fma_f32 v40, -v19, v39, v40
  v_fma_f32 v41, v19, v38, v41
  v_fma_f32 v38, v18, v40, v102
  v_fma_f32 v39, v18, v41, v103
  v_fma_f32 v38, -v19, v41, v38
  v_fma_f32 v39, v19, v40, v39
  s_cmp_le_u32 s62, 2
  s_cbranch_scc1 L_A_pdone
  v_fma_f32 v40, v18, v38, v104
  v_fma_f32 v41, v18, v39, v105
  v_fma_f32 v40, -v19, v39, v40
  v_fma_f32 v41, v19, v38, v41
  v_fma_f32 v38, v18, v40, v106
  v_fma_f32 v39, v18, v41, v107
  v_fma_f32 v38, -v19, v41, v38
  v_fma_f32 v39, v19, v40, v39
L_A_pdone:
  v_fma_f32 v40, v18, v38, v108
  v_fma_f32 v41, v18, v39, v109
  v_fma_f32 v40, -v19, v39, v40
  v_fma_f32 v41, v19, v38, v41
  v_cndmask_b32 v38, v40, v38, s[84:85]
  v_cndmask_b32 v39, v41, v39, s[84:85]
  s_lshl_b32 s69, s64, 13
  s_add_u32 s69, s69, 655360
  s_add_u32 s28, s60, s69
  s_addc_u32 s29, s61, 0
  s_mov_b32 s30, 8192
  s_mov_b32 s31, 0x00020000
  s_cmp_eq_u32 s62, 3
  s_cbranch_scc0 L_A_nopub
  v_fma_f32 v112, v18, v38, v30
  v_fma_f32 v113, v18, v39, v31
  v_fma_f32 v112, -v19, v39, v112
  v_fma_f32 v113, v19, v38, v113
  v_mov_b32 v114, s66
  v_mov_b32 v115, s66
  s_lshl_b32 s69, s63, 9
  v_lshlrev_b32 v40, 4, v14
  s_not_b64 exec, s[84:85]
  buffer_store_dwordx4 v[112:115], v40, s[28:31], s69 offen sc1
  s_mov_b64 exec, -1
L_A_nopub:
  s_sub_u32 s69, s63, 1
  v_sub_u32 v43, s69, v15
  v_lshlrev_b32 v40, 4, v14
  v_lshl_add_u32 v43, v43, 9, v40
  buffer_load_dwordx4 v[128:131], v43, s[28:31], 0 offen sc1
  v_subrev_u32 v209, 1024, v43
  buffer_load_dwordx4 v[132:135], v209, s[28:31], 0 offen sc1
  v_subrev_u32 v208, 2048, v43
  buffer_load_dwordx4 v[136:139], v208, s[28:31], 0 offen sc1
  v_subrev_u32 v209, 3072, v43
  buffer_load_dwordx4 v[140:143], v209, s[28:31], 0 offen sc1
  v_subrev_u32 v208, 4096, v43
  buffer_load_dwordx4 v[144:147], v208, s[28:31], 0 offen sc1
  v_subrev_u32 v209, 5120, v43
  buffer_load_dwordx4 v[148:151], v209, s[28:31], 0 offen sc1
  v_subrev_u32 v208, 6144, v43
  buffer_load_dwordx4 v[152:155], v208, s[28:31], 0 offen sc1
  v_subrev_u32 v209, 7168, v43
  buffer_load_dwordx4 v[156:159], v209, s[28:31], 0 offen sc1
  v_add_u32 v40, 0, v15
  v_cmp_gt_u32 vcc, s63, v40
  v_mov_b32 v41, s66
  s_nop 0
  v_cndmask_b32 v200, 0, v41, vcc
  v_add_u32 v40, 2, v15
  v_cmp_gt_u32 vcc, s63, v40
  v_mov_b32 v41, s66
  s_nop 0
  v_cndmask_b32 v201, 0, v41, vcc
  v_add_u32 v40, 4, v15
  v_cmp_gt_u32 vcc, s63, v40
  v_mov_b32 v41, s66
  s_nop 0
  v_cndmask_b32 v202, 0, v41, vcc
  v_add_u32 v40, 6, v15
  v_cmp_gt_u32 vcc, s63, v40
  v_mov_b32 v41, s66
  s_nop 0
  v_cndmask_b32 v203, 0, v41, vcc
  v_add_u32 v40, 8, v15
  v_cmp_gt_u32 vcc, s63, v40
  v_mov_b32 v41, s66
  s_nop 0
  v_cndmask_b32 v204, 0, v41, vcc
  v_add_u32 v40, 10, v15
  v_cmp_gt_u32 vcc, s63, v40
  v_mov_b32 v41, s66
  s_nop 0
  v_cndmask_b32 v205, 0, v41, vcc
  v_add_u32 v40, 12, v15
  v_cmp_gt_u32 vcc, s63, v40
  v_mov_b32 v41, s66
  s_nop 0
  v_cndmask_b32 v206, 0, v41, vcc
  v_add_u32 v40, 14, v15
  v_cmp_gt_u32 vcc, s63, v40
  v_mov_b32 v41, s66
  s_nop 0
  v_cndmask_b32 v207, 0, v41, vcc
  s_waitcnt vmcnt(8)
  s_mov_b32 s86, 0
L_A_gchk:
  v_xor_b32 v45, s66, v163
  v_xor_b32 v46, s66, v167
  v_or_b32 v45, v45, v46
  v_xor_b32 v46, s66, v171
  v_or_b32 v45, v45, v46
  v_xor_b32 v46, s66, v175
  v_or_b32 v45, v45, v46
  v_xor_b32 v46, s66, v179
  v_or_b32 v45, v45, v46
  v_xor_b32 v46, s66, v183
  v_or_b32 v45, v45, v46
  v_xor_b32 v46, s66, v187
  v_or_b32 v45, v45, v46
  v_xor_b32 v46, s66, v191
  v_or_b32 v45, v45, v46
  v_cmp_ne_u32 vcc, 0, v45
  s_add_u32 s86, s86, 1
  s_cbranch_vccnz L_A_gslow
L_A_gok:
  v_add_f32 v32, v160, v164
  v_add_f32 v32, v32, v168
  v_add_f32 v32, v32, v172
  v_add_f32 v32, v32, v176
  v_add_f32 v32, v32, v180
  v_add_f32 v32, v32, v184
  v_add_f32 v32, v32, v188
  v_add_f32 v33, v161, v165
  v_add_f32 v33, v33, v169
  v_add_f32 v33, v33, v173
  v_add_f32 v33, v33, v177
  v_add_f32 v33, v33, v181
  v_add_f32 v33, v33, v185
  v_add_f32 v33, v33, v189
  v_mov_b32 v34, v32
  v_mov_b32 v35, v33
  s_nop 0
  v_permlane32_swap_b32 v32, v34
  v_permlane32_swap_b32 v33, v35
  v_add_f32 v32, v32, v34
  v_add_f32 v33, v33, v35
  v_and_b32 v34, 0xffff0000, v32
  v_sub_f32 v32, v32, v34
  v_and_b32 v35, 0xffff0000, v32
  v_sub_f32 v32, v32, v35
  v_lshrrev_b32 v34, 16, v34
  v_or_b32 v160, v34, v35
  v_lshrrev_b32 v161, 16, v32
  v_and_b32 v34, 0xffff0000, v33
  v_sub_f32 v33, v33, v34
  v_and_b32 v35, 0xffff0000, v33
  v_sub_f32 v33, v33, v35
  v_lshrrev_b32 v34, 16, v34
  v_or_b32 v162, v34, v35
  v_lshrrev_b32 v163, 16, v33
  s_lshl_b32 s69, s62, 8
  s_add_u32 s69, s69, 154624
  v_lshlrev_b32 v34, 3, v14
  v_add_u32 v34, s69, v34
  v_mov_b32 v35, 2
  s_mov_b64 exec, s[84:85]
  ds_write_b64 v34, v[160:161]
  s_cmp_lt_u32 s62, 3
  s_cbranch_scc0 L_A_nor
  ds_write_b64 v34, v[162:163] offset:1024
L_A_nor:
  s_mov_b64 exec, -1
  ds_write_b32 v12, v35
  v_mul_f32 v45, v27, v64
  v_mul_f32 v46, v27, v48
  v_fma_f32 v48, v26, v48, -v45
  v_fma_f32 v64, v26, v64, v46
  v_mul_f32 v45, v27, v65
  v_mul_f32 v46, v27, v49
  v_fma_f32 v49, v26, v49, -v45
  v_fma_f32 v65, v26, v65, v46
  v_mul_f32 v45, v27, v66
  v_mul_f32 v46, v27, v50
  v_fma_f32 v50, v26, v50, -v45
  v_fma_f32 v66, v26, v66, v46
  v_mul_f32 v45, v27, v67
  v_mul_f32 v46, v27, v51
  v_fma_f32 v51, v26, v51, -v45
  v_fma_f32 v67, v26, v67, v46
  v_mul_f32 v45, v27, v68
  v_mul_f32 v46, v27, v52
  v_fma_f32 v52, v26, v52, -v45
  v_fma_f32 v68, v26, v68, v46
  v_mul_f32 v45, v27, v69
  v_mul_f32 v46, v27, v53
  v_fma_f32 v53, v26, v53, -v45
  v_fma_f32 v69, v26, v69, v46
  v_mul_f32 v45, v27, v70
  v_mul_f32 v46, v27, v54
  v_fma_f32 v54, v26, v54, -v45
  v_fma_f32 v70, v26, v70, v46
  v_mul_f32 v45, v27, v71
  v_mul_f32 v46, v27, v55
  v_fma_f32 v55, v26, v55, -v45
  v_fma_f32 v71, v26, v71, v46
  v_mul_f32 v45, v27, v72
  v_mul_f32 v46, v27, v56
  v_fma_f32 v56, v26, v56, -v45
  v_fma_f32 v72, v26, v72, v46
  v_mul_f32 v45, v27, v73
  v_mul_f32 v46, v27, v57
  v_fma_f32 v57, v26, v57, -v45
  v_fma_f32 v73, v26, v73, v46
  v_mul_f32 v45, v27, v74
  v_mul_f32 v46, v27, v58
  v_fma_f32 v58, v26, v58, -v45
  v_fma_f32 v74, v26, v74, v46
  v_mul_f32 v45, v27, v75
  v_mul_f32 v46, v27, v59
  v_fma_f32 v59, v26, v59, -v45
  v_fma_f32 v75, v26, v75, v46
  v_mul_f32 v45, v27, v76
  v_mul_f32 v46, v27, v60
  v_fma_f32 v60, v26, v60, -v45
  v_fma_f32 v76, v26, v76, v46
  v_mul_f32 v45, v27, v77
  v_mul_f32 v46, v27, v61
  v_fma_f32 v61, v26, v61, -v45
  v_fma_f32 v77, v26, v77, v46
  v_mul_f32 v45, v27, v78
  v_mul_f32 v46, v27, v62
  v_fma_f32 v62, v26, v62, -v45
  v_fma_f32 v78, v26, v78, v46
  v_mul_f32 v45, v27, v79
  v_mul_f32 v46, v27, v63
  v_fma_f32 v63, v26, v63, -v45
  v_fma_f32 v79, v26, v79, v46
  v_mul_f32 v40, v26, v38
  v_mul_f32 v41, v26, v39
  v_fma_f32 v40, -v27, v39, v40
  v_fma_f32 v41, v27, v38, v41
  v_mul_f32 v30, v26, v24
  v_mul_f32 v31, v26, v25
  v_fma_f32 v30, -v27, v25, v30
  v_fma_f32 v31, v27, v24, v31
  s_waitcnt vmcnt(0)
  s_mov_b32 s86, 0
L_A_cchk:
  v_xor_b32 v45, v200, v130
  v_xor_b32 v46, v201, v134
  v_or_b32 v45, v45, v46
  v_xor_b32 v46, v202, v138
  v_xor_b32 v47, v203, v142
  v_or3_b32 v45, v45, v46, v47
  v_xor_b32 v46, v204, v146
  v_xor_b32 v47, v205, v150
  v_or3_b32 v45, v45, v46, v47
  v_xor_b32 v46, v206, v154
  v_xor_b32 v47, v207, v158
  v_or3_b32 v45, v45, v46, v47
  v_cmp_ne_u32 vcc, 0, v45
  s_add_u32 s86, s86, 1
  s_cbranch_vccnz L_A_cslow
L_A_cok:
  v_fma_f32 v32, v22, v156, v152
  v_fma_f32 v33, v22, v157, v153
  v_fma_f32 v32, -v23, v157, v32
  v_fma_f32 v33, v23, v156, v33
  v_fma_f32 v34, v22, v32, v148
  v_fma_f32 v35, v22, v33, v149
  v_fma_f32 v34, -v23, v33, v34
  v_fma_f32 v35, v23, v32, v35
  v_fma_f32 v32, v22, v34, v144
  v_fma_f32 v33, v22, v35, v145
  v_fma_f32 v32, -v23, v35, v32
  v_fma_f32 v33, v23, v34, v33
  v_fma_f32 v34, v22, v32, v140
  v_fma_f32 v35, v22, v33, v141
  v_fma_f32 v34, -v23, v33, v34
  v_fma_f32 v35, v23, v32, v35
  v_fma_f32 v32, v22, v34, v136
  v_fma_f32 v33, v22, v35, v137
  v_fma_f32 v32, -v23, v35, v32
  v_fma_f32 v33, v23, v34, v33
  v_fma_f32 v34, v22, v32, v132
  v_fma_f32 v35, v22, v33, v133
  v_fma_f32 v34, -v23, v33, v34
  v_fma_f32 v35, v23, v32, v35
  v_fma_f32 v32, v22, v34, v128
  v_fma_f32 v33, v22, v35, v129
  v_fma_f32 v32, -v23, v35, v32
  v_fma_f32 v33, v23, v34, v33
  v_mov_b32 v34, v32
  v_mov_b32 v35, v33
  s_nop 0
  v_permlane32_swap_b32 v32, v34
  v_permlane32_swap_b32 v33, v35
  v_fma_f32 v36, v20, v34, v32
  v_fma_f32 v37, v20, v35, v33
  v_fma_f32 v36, -v21, v35, v36
  v_fma_f32 v37, v21, v34, v37
  v_fma_f32 v38, v30, v36, v40
  v_fma_f32 v39, v30, v37, v41
  v_fma_f32 v38, -v31, v37, v38
  v_fma_f32 v39, v31, v36, v39
  s_lshl_b32 s69, s67, 1
  s_lshr_b32 s70, s62, 1
  s_add_u32 s69, s69, s70
  s_lshl_b32 s77, s69, 8
  s_add_u32 s77, s77, 32768
  v_lshlrev_b32 v250, 2, v1
  v_fma_f32 v48, v16, v38, v48
  v_fma_f32 v64, v16, v39, v64
  v_fma_f32 v48, -v17, v39, v48
  v_fma_f32 v64, v17, v38, v64
  v_fma_f32 v49, v16, v48, v49
  v_fma_f32 v65, v16, v64, v65
  v_fma_f32 v49, -v17, v64, v49
  v_fma_f32 v65, v17, v48, v65
  v_fma_f32 v50, v16, v49, v50
  v_fma_f32 v66, v16, v65, v66
  v_fma_f32 v50, -v17, v65, v50
  v_fma_f32 v66, v17, v49, v66
  v_fma_f32 v51, v16, v50, v51
  v_fma_f32 v67, v16, v66, v67
  v_fma_f32 v51, -v17, v66, v51
  v_fma_f32 v67, v17, v50, v67
  v_fma_f32 v52, v16, v51, v52
  v_fma_f32 v68, v16, v67, v68
  v_fma_f32 v52, -v17, v67, v52
  v_fma_f32 v68, v17, v51, v68
  v_fma_f32 v53, v16, v52, v53
  v_fma_f32 v69, v16, v68, v69
  v_fma_f32 v53, -v17, v68, v53
  v_fma_f32 v69, v17, v52, v69
  v_fma_f32 v54, v16, v53, v54
  v_fma_f32 v70, v16, v69, v70
  v_fma_f32 v54, -v17, v69, v54
  v_fma_f32 v70, v17, v53, v70
  v_fma_f32 v55, v16, v54, v55
  v_fma_f32 v71, v16, v70, v71
  v_fma_f32 v55, -v17, v70, v55
  v_fma_f32 v71, v17, v54, v71
  v_fma_f32 v56, v16, v55, v56
  v_fma_f32 v72, v16, v71, v72
  v_fma_f32 v56, -v17, v71, v56
  v_fma_f32 v72, v17, v55, v72
  v_fma_f32 v57, v16, v56, v57
  v_fma_f32 v73, v16, v72, v73
  v_fma_f32 v57, -v17, v72, v57
  v_fma_f32 v73, v17, v56, v73
  v_fma_f32 v58, v16, v57, v58
  v_fma_f32 v74, v16, v73, v74
  v_fma_f32 v58, -v17, v73, v58
  v_fma_f32 v74, v17, v57, v74
  v_fma_f32 v59, v16, v58, v59
  v_fma_f32 v75, v16, v74, v75
  v_fma_f32 v59, -v17, v74, v59
  v_fma_f32 v75, v17, v58, v75
  v_fma_f32 v60, v16, v59, v60
  v_fma_f32 v76, v16, v75, v76
  v_fma_f32 v60, -v17, v75, v60
  v_fma_f32 v76, v17, v59, v76
  v_fma_f32 v61, v16, v60, v61
  v_fma_f32 v77, v16, v76, v77
  v_fma_f32 v61, -v17, v76, v61
  v_fma_f32 v77, v17, v60, v77
  v_fma_f32 v62, v16, v61, v62
  v_fma_f32 v78, v16, v77, v78
  v_fma_f32 v62, -v17, v77, v62
  v_fma_f32 v78, v17, v61, v78
  v_fma_f32 v63, v16, v62, v63
  v_fma_f32 v79, v16, v78, v79
  v_fma_f32 v63, -v17, v78, v63
  v_fma_f32 v79, v17, v62, v79
  v_cvt_pk_bf16_f32 v96, v48, v49
  v_cvt_pk_bf16_f32 v97, v50, v51
  v_cvt_pk_bf16_f32 v98, v52, v53
  v_cvt_pk_bf16_f32 v99, v54, v55
  v_cvt_pk_bf16_f32 v100, v56, v57
  v_cvt_pk_bf16_f32 v101, v58, v59
  v_cvt_pk_bf16_f32 v102, v60, v61
  v_cvt_pk_bf16_f32 v103, v62, v63
  v_cvt_pk_bf16_f32 v104, -v64, -v65
  v_cvt_pk_bf16_f32 v105, -v66, -v67
  v_cvt_pk_bf16_f32 v106, -v68, -v69
  v_cvt_pk_bf16_f32 v107, -v70, -v71
  v_cvt_pk_bf16_f32 v108, -v72, -v73
  v_cvt_pk_bf16_f32 v109, -v74, -v75
  v_cvt_pk_bf16_f32 v110, -v76, -v77
  v_cvt_pk_bf16_f32 v111, -v78, -v79
  s_lshl_b32 s71, s63, 2
  s_add_u32 s71, s71, s62
  s_lshl_b32 s89, s71, 16
  s_lshl_b32 s70, s64, 11
  s_add_u32 s89, s89, s70
  s_add_u32 s89, s89, 8388608
  s_lshl_b32 s91, s71, 8
  s_lshl_b32 s70, s64, 2
  s_add_u32 s91, s91, s70
  s_add_u32 s91, s91, 32768
  v_lshrrev_b32 v45, 2, v14
  v_lshlrev_b32 v45, 8, v45
  v_lshl_add_u32 v45, v15, 6, v45
  v_and_b32 v46, 3, v14
  v_lshl_add_u32 v45, v46, 4, v45
  s_add_u32 s72, s89, 32768
  buffer_store_dwordx4 v[96:99], v45, s[8:11], s89 offen offset:0 sc1
  buffer_store_dwordx4 v[100:103], v45, s[8:11], s89 offen offset:128 sc1
  buffer_store_dwordx4 v[104:107], v45, s[8:11], s72 offen offset:0 sc1
  buffer_store_dwordx4 v[108:111], v45, s[8:11], s72 offen offset:128 sc1
  v_lshrrev_b32 v28, 3, v1
  v_and_b32 v29, 7, v1
  v_lshrrev_b32 v30, 1, v28
  v_and_b32 v31, 1, v30
  v_lshlrev_b32 v31, 2, v31
  v_xor_b32 v31, v29, v31
  v_lshlrev_b32 v31, 4, v31
  v_lshlrev_b32 v32, 10, v28
  v_add_u32 v245, v32, v31
  v_xor_b32 v31, v29, v30
  v_lshlrev_b32 v33, 4, v31
  v_add_u32 v246, v32, v33
  v_xor_b32 v31, 4, v31
  v_lshlrev_b32 v33, 4, v31
  v_add_u32 v247, v32, v33
  v_lshlrev_b32 v244, 4, v1
  s_and_b32 s70, s62, 1
  s_lshl_b32 s70, s70, 11
  s_mul_i32 s73, s69, 114688
  s_add_u32 s73, s73, s70
  s_add_u32 s73, s73, 1046528
  s_lshl_b32 s74, s69, 16
  s_add_u32 s74, s74, s70
  s_add_u32 s74, s74, 8386560
  s_lshl_b32 s75, s62, 14
  s_lshl_b32 s70, s68, 7
  s_add_u32 s75, s75, s70
  s_lshl_b32 s76, s68, 16
  s_lshl_b32 s70, s62, 14
  s_add_u32 s76, s76, s70
  s_mov_b32 s12, s56
  s_mov_b32 s13, s57
  s_mov_b32 s14, 0x1c0000
  s_mov_b32 s15, 0x00020000
  s_mov_b32 s16, s42
  s_mov_b32 s17, s43
  s_mov_b32 s18, 0x80000
  s_mov_b32 s19, 0x00020000
  s_mov_b32 s20, s44
  s_mov_b32 s21, s45
  s_mov_b32 s22, 0x80000
  s_mov_b32 s23, 0x00020000
  s_mov_b32 s92, 0xffff
  s_mov_b32 s93, 0x0
  s_mov_b32 s94, 0xffff0000
  s_mov_b32 s95, 0x0
  s_mov_b32 s96, 0x0
  s_mov_b32 s97, 0xffff
  s_waitcnt vmcnt(0)
  v_mov_b32 v28, s66
  v_mov_b32 v29, 0
  s_mov_b64 exec, 1
  buffer_store_dword v28, v29, s[8:11], s91 offen sc1
  s_mov_b64 exec, -1
  v_lshlrev_b32 v40, 4, v1
  v_add_u32 v40, s83, v40
  v_add_u32 v41, 0x10000, v40
  v_add_u32 v42, 0x20000, v40
  s_mov_b32 s86, 0
L_A_hw:
  s_sleep 4
  ds_read_b32 v37, v13 offset:1024
  s_waitcnt lgkmcnt(0)
  v_cmp_gt_u32 vcc, 12, v37
  s_cbranch_vccz L_A_hwk
  s_add_u32 s86, s86, 1
  s_cmp_lt_u32 s86, 200000
  s_cbranch_scc1 L_A_hw
L_A_hwk:
  s_add_u32 s78, s76, 0
  s_add_u32 s79, s76, 8192
  buffer_load_dwordx4 v[48:51], v246, s[16:19], s78 offen
  buffer_load_dwordx4 v[52:55], v247, s[16:19], s79 offen
  s_add_u32 s78, s76, 0
  s_add_u32 s79, s76, 8192
  buffer_load_dwordx4 v[56:59], v246, s[20:23], s78 offen
  buffer_load_dwordx4 v[60:63], v247, s[20:23], s79 offen
  s_add_u32 s78, s76, 128
  s_add_u32 s79, s76, 8320
  buffer_load_dwordx4 v[64:67], v246, s[16:19], s78 offen
  buffer_load_dwordx4 v[68:71], v247, s[16:19], s79 offen
  s_add_u32 s78, s76, 128
  s_add_u32 s79, s76, 8320
  buffer_load_dwordx4 v[72:75], v246, s[20:23], s78 offen
  buffer_load_dwordx4 v[76:79], v247, s[20:23], s79 offen
  s_add_u32 s78, s76, 256
  s_add_u32 s79, s76, 8448
  buffer_load_dwordx4 v[80:83], v246, s[16:19], s78 offen
  buffer_load_dwordx4 v[84:87], v247, s[16:19], s79 offen
  s_add_u32 s78, s76, 256
  s_add_u32 s79, s76, 8448
  buffer_load_dwordx4 v[88:91], v246, s[20:23], s78 offen
  buffer_load_dwordx4 v[92:95], v247, s[20:23], s79 offen
  s_add_u32 s78, s76, 384
  s_add_u32 s79, s76, 8576
  buffer_load_dwordx4 v[96:99], v246, s[16:19], s78 offen
  buffer_load_dwordx4 v[100:103], v247, s[16:19], s79 offen
  s_add_u32 s78, s76, 384
  s_add_u32 s79, s76, 8576
  buffer_load_dwordx4 v[104:107], v246, s[20:23], s78 offen
  buffer_load_dwordx4 v[108:111], v247, s[20:23], s79 offen
  s_add_u32 s78, s76, 512
  s_add_u32 s79, s76, 8704
  buffer_load_dwordx4 v[112:115], v246, s[16:19], s78 offen
  buffer_load_dwordx4 v[116:119], v247, s[16:19], s79 offen
  buffer_load_dword v251, v250, s[8:11], s77 offen sc1
  s_waitcnt vmcnt(0)
  v_cmp_ne_u32 vcc, s66, v251
  s_and_b64 vcc, vcc, s[92:93]
  s_cbranch_vccnz L_f0_s
L_f0_k:
  s_or_b32 s70, s2, s62
  s_cmp_eq_u32 s70, 0
  s_cbranch_scc0 L_A_nobump
  v_mov_b32 v28, s66
  v_mov_b32 v29, 0
  s_mov_b64 exec, 1
  buffer_store_dword v28, v29, s[8:11], 0 offen sc1
  s_mov_b64 exec, -1
L_A_nobump:
  ds_read_b32 v37, v13 offset:1024
  s_waitcnt lgkmcnt(0)
  v_cmp_gt_u32 vcc, 9, v37
  s_cbranch_vccnz L_g0_s
L_g0_k:
  s_add_u32 s78, s76, 0
  s_add_u32 s79, s76, 7168
  s_add_u32 s80, s74, 0
  s_add_u32 m0, s83, 98304
  ds_write_b128 v41, v[48:51] offset:32768
  ds_write_b128 v41, v[52:55] offset:33792
  buffer_load_dwordx4 v244, s[8:11], s80 offen offset:2048 sc1 lds
  buffer_load_dwordx4 v244, s[8:11], s80 offen offset:3072 sc1 lds
  ds_read_b32 v37, v13 offset:1024
  s_waitcnt lgkmcnt(0)
  v_cmp_gt_u32 vcc, 10, v37
  s_cbranch_vccnz L_g1_s
L_g1_k:
  s_add_u32 s78, s76, 0
  s_add_u32 s79, s76, 7168
  s_add_u32 s80, s74, 32768
  s_add_u32 m0, s83, 131072
  ds_write_b128 v42, v[56:59] offset:0
  ds_write_b128 v42, v[60:63] offset:1024
  buffer_load_dwordx4 v244, s[8:11], s80 offen offset:2048 sc1 lds
  buffer_load_dwordx4 v244, s[8:11], s80 offen offset:3072 sc1 lds
  ds_read_b32 v37, v13 offset:1024
  s_waitcnt lgkmcnt(0)
  v_cmp_gt_u32 vcc, 11, v37
  s_cbranch_vccnz L_g2_s
L_g2_k:
  s_add_u32 s78, s76, 128
  s_add_u32 s79, s76, 7296
  s_add_u32 s80, s74, 4096
  s_add_u32 m0, s83, 114688
  ds_write_b128 v41, v[64:67] offset:49152
  ds_write_b128 v41, v[68:71] offset:50176
  buffer_load_dwordx4 v244, s[8:11], s80 offen offset:2048 sc1 lds
  buffer_load_dwordx4 v244, s[8:11], s80 offen offset:3072 sc1 lds
  ds_read_b32 v37, v13 offset:1024
  s_waitcnt lgkmcnt(0)
  v_cmp_gt_u32 vcc, 12, v37
  s_cbranch_vccnz L_g3_s
L_g3_k:
  s_add_u32 s78, s76, 128
  s_add_u32 s79, s76, 7296
  s_add_u32 s80, s74, 36864
  s_add_u32 m0, s83, 49152
  ds_write_b128 v40, v[72:75] offset:49152
  ds_write_b128 v40, v[76:79] offset:50176
  buffer_load_dwordx4 v244, s[8:11], s80 offen offset:2048 sc1 lds
  buffer_load_dwordx4 v244, s[8:11], s80 offen offset:3072 sc1 lds
  ds_read_b32 v37, v13 offset:1024
  s_waitcnt lgkmcnt(0)
  v_cmp_gt_u32 vcc, 13, v37
  s_cbranch_vccnz L_g4_s
L_g4_k:
  s_add_u32 s78, s76, 256
  s_add_u32 s79, s76, 7424
  s_add_u32 s80, s74, 8192
  s_add_u32 m0, s83, 65536
  ds_write_b128 v41, v[80:83] offset:0
  ds_write_b128 v41, v[84:87] offset:1024
  buffer_load_dwordx4 v244, s[8:11], s80 offen offset:2048 sc1 lds
  buffer_load_dwordx4 v244, s[8:11], s80 offen offset:3072 sc1 lds
  ds_read_b32 v37, v13 offset:1024
  s_waitcnt lgkmcnt(0)
  v_cmp_gt_u32 vcc, 14, v37
  s_cbranch_vccnz L_g5_s
L_g5_k:
  s_add_u32 s78, s76, 256
  s_add_u32 s79, s76, 7424
  s_add_u32 s80, s74, 40960
  s_add_u32 m0, s83, 0
  ds_write_b128 v40, v[88:91] offset:0
  ds_write_b128 v40, v[92:95] offset:1024
  buffer_load_dwordx4 v244, s[8:11], s80 offen offset:2048 sc1 lds
  buffer_load_dwordx4 v244, s[8:11], s80 offen offset:3072 sc1 lds
  ds_read_b32 v37, v13 offset:1024
  s_waitcnt lgkmcnt(0)
  v_cmp_gt_u32 vcc, 15, v37
  s_cbranch_vccnz L_g6_s
L_g6_k:
  s_add_u32 s78, s76, 384
  s_add_u32 s79, s76, 7552
  s_add_u32 s80, s74, 12288
  s_add_u32 m0, s83, 81920
  ds_write_b128 v41, v[96:99] offset:16384
  ds_write_b128 v41, v[100:103] offset:17408
  buffer_load_dwordx4 v244, s[8:11], s80 offen offset:2048 sc1 lds
  buffer_load_dwordx4 v244, s[8:11], s80 offen offset:3072 sc1 lds
  ds_read_b32 v37, v13 offset:1024
  s_waitcnt lgkmcnt(0)
  v_cmp_gt_u32 vcc, 16, v37
  s_cbranch_vccnz L_g7_s
L_g7_k:
  s_add_u32 s78, s76, 384
  s_add_u32 s79, s76, 7552
  s_add_u32 s80, s74, 45056
  s_add_u32 m0, s83, 16384
  ds_write_b128 v40, v[104:107] offset:16384
  ds_write_b128 v40, v[108:111] offset:17408
  buffer_load_dwordx4 v244, s[8:11], s80 offen offset:2048 sc1 lds
  buffer_load_dwordx4 v244, s[8:11], s80 offen offset:3072 sc1 lds
  ds_read_b32 v37, v13 offset:1024
  s_waitcnt lgkmcnt(0)
  v_cmp_gt_u32 vcc, 17, v37
  s_cbranch_vccnz L_g8_s
L_g8_k:
  s_add_u32 s78, s76, 512
  s_add_u32 s79, s76, 7680
  s_add_u32 s80, s74, 16384
  s_add_u32 m0, s83, 32768
  ds_write_b128 v40, v[112:115] offset:32768
  ds_write_b128 v40, v[116:119] offset:33792
  buffer_load_dwordx4 v244, s[8:11], s80 offen offset:2048 sc1 lds
  buffer_load_dwordx4 v244, s[8:11], s80 offen offset:3072 sc1 lds
  s_waitcnt vmcnt(16)
  s_barrier
  s_waitcnt vmcnt(14)
  s_barrier
  s_waitcnt vmcnt(12)
  s_barrier
  s_add_u32 s78, s76, 512
  s_add_u32 s79, s76, 7680
  s_add_u32 s80, s74, 49152
  s_add_u32 m0, s83, 98304
  s_nop 0
  buffer_load_dwordx4 v246, s[20:23], s78 offen lds
  buffer_load_dwordx4 v247, s[20:23], s79 offen offset:1024 lds
  buffer_load_dwordx4 v244, s[8:11], s80 offen offset:2048 sc1 lds
  buffer_load_dwordx4 v244, s[8:11], s80 offen offset:3072 sc1 lds
  s_waitcnt vmcnt(14)
  s_barrier
  s_add_u32 s78, s76, 640
  s_add_u32 s79, s76, 7808
  s_add_u32 s80, s74, 20480
  s_add_u32 m0, s83, 131072
  s_nop 0
  buffer_load_dwordx4 v246, s[16:19], s78 offen lds
  buffer_load_dwordx4 v247, s[16:19], s79 offen offset:1024 lds
  buffer_load_dwordx4 v244, s[8:11], s80 offen offset:2048 sc1 lds
  buffer_load_dwordx4 v244, s[8:11], s80 offen offset:3072 sc1 lds
  s_waitcnt vmcnt(16)
  s_barrier
  s_add_u32 s78, s75, 0
  s_add_u32 s79, s75, 7168
  s_add_u32 s80, s73, 0
  s_add_u32 m0, s83, 114688
  s_nop 0
  buffer_load_dwordx4 v245, s[12:15], s78 offen lds
  buffer_load_dwordx4 v245, s[12:15], s79 offen offset:1024 lds
  buffer_load_dwordx4 v244, s[8:11], s80 offen offset:2048 sc1 lds
  buffer_load_dwordx4 v244, s[8:11], s80 offen offset:3072 sc1 lds
  s_waitcnt vmcnt(18)
  s_barrier
  s_add_u32 s78, s75, 65536
  s_add_u32 s79, s75, 72704
  s_add_u32 s80, s73, 4096
  s_add_u32 m0, s83, 49152
  s_nop 0
  buffer_load_dwordx4 v245, s[12:15], s78 offen lds
  buffer_load_dwordx4 v245, s[12:15], s79 offen offset:1024 lds
  buffer_load_dwordx4 v244, s[8:11], s80 offen offset:2048 sc1 lds
  buffer_load_dwordx4 v244, s[8:11], s80 offen offset:3072 sc1 lds
  s_waitcnt vmcnt(20)
  s_barrier
  s_add_u32 s78, s75, 131072
  s_add_u32 s79, s75, 138240
  s_add_u32 s80, s73, 8192
  s_add_u32 m0, s83, 65536
  s_nop 0
  buffer_load_dwordx4 v245, s[12:15], s78 offen lds
  buffer_load_dwordx4 v245, s[12:15], s79 offen offset:1024 lds
  buffer_load_dwordx4 v244, s[8:11], s80 offen offset:2048 sc1 lds
  buffer_load_dwordx4 v244, s[8:11], s80 offen offset:3072 sc1 lds
  s_waitcnt vmcnt(22)
  s_barrier
  s_add_u32 s78, s75, 196608
  s_add_u32 s79, s75, 203776
  s_add_u32 s80, s73, 12288
  s_add_u32 m0, s83, 0
  s_nop 0
  buffer_load_dwordx4 v245, s[12:15], s78 offen lds
  buffer_load_dwordx4 v245, s[12:15], s79 offen offset:1024 lds
  buffer_load_dwordx4 v244, s[8:11], s80 offen offset:2048 sc1 lds
  buffer_load_dwordx4 v244, s[8:11], s80 offen offset:3072 sc1 lds
  s_waitcnt vmcnt(24)
  s_waitcnt lgkmcnt(0)
  s_barrier
  s_add_u32 s78, s75, 262144
  s_add_u32 s79, s75, 269312
  s_add_u32 s80, s73, 16384
  s_add_u32 m0, s83, 81920
  s_nop 0
  buffer_load_dwordx4 v245, s[12:15], s78 offen lds
  buffer_load_dwordx4 v245, s[12:15], s79 offen offset:1024 lds
  buffer_load_dwordx4 v244, s[8:11], s80 offen offset:2048 sc1 lds
  buffer_load_dwordx4 v244, s[8:11], s80 offen offset:3072 sc1 lds
  s_waitcnt vmcnt(24)
  s_barrier
  s_add_u32 s78, s75, 327680
  s_add_u32 s79, s75, 334848
  s_add_u32 s80, s73, 20480
  s_add_u32 m0, s83, 16384
  s_nop 0
  buffer_load_dwordx4 v245, s[12:15], s78 offen lds
  buffer_load_dwordx4 v245, s[12:15], s79 offen offset:1024 lds
  buffer_load_dwordx4 v244, s[8:11], s80 offen offset:2048 sc1 lds
  buffer_load_dwordx4 v244, s[8:11], s80 offen offset:3072 sc1 lds
  s_waitcnt vmcnt(24)
  s_barrier
  s_add_u32 s78, s75, 393216
  s_add_u32 s79, s75, 400384
  s_add_u32 s80, s73, 24576
  s_add_u32 m0, s83, 32768
  s_nop 0
  buffer_load_dwordx4 v245, s[12:15], s78 offen lds
  buffer_load_dwordx4 v245, s[12:15], s79 offen offset:1024 lds
  buffer_load_dwordx4 v244, s[8:11], s80 offen offset:2048 sc1 lds
  buffer_load_dwordx4 v244, s[8:11], s80 offen offset:3072 sc1 lds
  s_waitcnt vmcnt(24)
  s_barrier
  s_add_u32 s78, s75, 458752
  s_add_u32 s79, s75, 465920
  s_add_u32 s80, s73, 28672
  s_add_u32 m0, s83, 98304
  s_nop 0
  buffer_load_dwordx4 v245, s[12:15], s78 offen lds
  buffer_load_dwordx4 v245, s[12:15], s79 offen offset:1024 lds
  buffer_load_dwordx4 v244, s[8:11], s80 offen offset:2048 sc1 lds
  buffer_load_dwordx4 v244, s[8:11], s80 offen offset:3072 sc1 lds
  s_waitcnt vmcnt(24)
  s_barrier
  s_add_u32 s78, s75, 524288
  s_add_u32 s79, s75, 531456
  s_add_u32 s80, s73, 32768
  s_add_u32 m0, s83, 131072
  s_nop 0
  buffer_load_dwordx4 v245, s[12:15], s78 offen lds
  buffer_load_dwordx4 v245, s[12:15], s79 offen offset:1024 lds
  buffer_load_dwordx4 v244, s[8:11], s80 offen offset:2048 sc1 lds
  buffer_load_dwordx4 v244, s[8:11], s80 offen offset:3072 sc1 lds
  s_waitcnt vmcnt(24)
  s_barrier
  s_add_u32 s78, s75, 589824
  s_add_u32 s79, s75, 596992
  s_add_u32 s80, s73, 36864
  s_add_u32 m0, s83, 114688
  s_nop 0
  buffer_load_dwordx4 v245, s[12:15], s78 offen lds
  buffer_load_dwordx4 v245, s[12:15], s79 offen offset:1024 lds
  buffer_load_dwordx4 v244, s[8:11], s80 offen offset:2048 sc1 lds
  buffer_load_dwordx4 v244, s[8:11], s80 offen offset:3072 sc1 lds
  s_waitcnt vmcnt(24)
  s_barrier
  s_add_u32 s78, s75, 655360
  s_add_u32 s79, s75, 662528
  s_add_u32 s80, s73, 40960
  s_add_u32 m0, s83, 49152
  s_nop 0
  buffer_load_dwordx4 v245, s[12:15], s78 offen lds
  buffer_load_dwordx4 v245, s[12:15], s79 offen offset:1024 lds
  buffer_load_dwordx4 v244, s[8:11], s80 offen offset:2048 sc1 lds
  buffer_load_dwordx4 v244, s[8:11], s80 offen offset:3072 sc1 lds
  s_waitcnt vmcnt(24)
  s_barrier
  s_add_u32 s78, s75, 720896
  s_add_u32 s79, s75, 728064
  s_add_u32 s80, s73, 45056
  s_add_u32 m0, s83, 65536
  s_nop 0
  buffer_load_dwordx4 v245, s[12:15], s78 offen lds
  buffer_load_dwordx4 v245, s[12:15], s79 offen offset:1024 lds
  buffer_load_dwordx4 v244, s[8:11], s80 offen offset:2048 sc1 lds
  buffer_load_dwordx4 v244, s[8:11], s80 offen offset:3072 sc1 lds
  s_waitcnt vmcnt(24)
  s_barrier
  s_add_u32 s78, s75, 786432
  s_add_u32 s79, s75, 793600
  s_add_u32 s80, s73, 49152
  s_add_u32 m0, s83, 0
  s_nop 0
  buffer_load_dwordx4 v245, s[12:15], s78 offen lds
  buffer_load_dwordx4 v245, s[12:15], s79 offen offset:1024 lds
  buffer_load_dwordx4 v244, s[8:11], s80 offen offset:2048 sc1 lds
  buffer_load_dwordx4 v244, s[8:11], s80 offen offset:3072 sc1 lds
  s_waitcnt vmcnt(24)
  s_barrier
  s_add_u32 s78, s75, 851968
  s_add_u32 s79, s75, 859136
  s_add_u32 s80, s73, 53248
  s_add_u32 m0, s83, 81920
  s_nop 0
  buffer_load_dwordx4 v245, s[12:15], s78 offen lds
  buffer_load_dwordx4 v245, s[12:15], s79 offen offset:1024 lds
  buffer_load_dwordx4 v244, s[8:11], s80 offen offset:2048 sc1 lds
  buffer_load_dwordx4 v244, s[8:11], s80 offen offset:3072 sc1 lds
  s_waitcnt vmcnt(24)
  s_barrier
  s_add_u32 s78, s75, 917504
  s_add_u32 s79, s75, 924672
  s_add_u32 s80, s73, 57344
  s_add_u32 m0, s83, 16384
  s_nop 0
  buffer_load_dwordx4 v245, s[12:15], s78 offen lds
  buffer_load_dwordx4 v245, s[12:15], s79 offen offset:1024 lds
  buffer_load_dwordx4 v244, s[8:11], s80 offen offset:2048 sc1 lds
  buffer_load_dwordx4 v244, s[8:11], s80 offen offset:3072 sc1 lds
  s_waitcnt vmcnt(24)
  s_barrier
  s_add_u32 s78, s75, 983040
  s_add_u32 s79, s75, 990208
  s_add_u32 s80, s73, 61440
  s_add_u32 m0, s83, 32768
  s_nop 0
  buffer_load_dwordx4 v245, s[12:15], s78 offen lds
  buffer_load_dwordx4 v245, s[12:15], s79 offen offset:1024 lds
  buffer_load_dwordx4 v244, s[8:11], s80 offen offset:2048 sc1 lds
  buffer_load_dwordx4 v244, s[8:11], s80 offen offset:3072 sc1 lds
  s_waitcnt vmcnt(24)
  s_barrier
  s_add_u32 s78, s75, 1048576
  s_add_u32 s79, s75, 1055744
  s_add_u32 s80, s73, 65536
  s_add_u32 m0, s83, 98304
  s_nop 0
  buffer_load_dwordx4 v245, s[12:15], s78 offen lds
  buffer_load_dwordx4 v245, s[12:15], s79 offen offset:1024 lds
  buffer_load_dwordx4 v244, s[8:11], s80 offen offset:2048 sc1 lds
  buffer_load_dwordx4 v244, s[8:11], s80 offen offset:3072 sc1 lds
  s_waitcnt vmcnt(24)
  s_barrier
  s_add_u32 s78, s75, 1114112
  s_add_u32 s79, s75, 1121280
  s_add_u32 s80, s73, 69632
  s_add_u32 m0, s83, 131072
  s_nop 0
  buffer_load_dwordx4 v245, s[12:15], s78 offen lds
  buffer_load_dwordx4 v245, s[12:15], s79 offen offset:1024 lds
  buffer_load_dwordx4 v244, s[8:11], s80 offen offset:2048 sc1 lds
  buffer_load_dwordx4 v244, s[8:11], s80 offen offset:3072 sc1 lds
  s_waitcnt vmcnt(24)
  s_barrier
  s_add_u32 s78, s75, 1179648
  s_add_u32 s79, s75, 1186816
  s_add_u32 s80, s73, 73728
  s_add_u32 m0, s83, 114688
  s_nop 0
  buffer_load_dwordx4 v245, s[12:15], s78 offen lds
  buffer_load_dwordx4 v245, s[12:15], s79 offen offset:1024 lds
  buffer_load_dwordx4 v244, s[8:11], s80 offen offset:2048 sc1 lds
  buffer_load_dwordx4 v244, s[8:11], s80 offen offset:3072 sc1 lds
  s_waitcnt vmcnt(24)
  s_barrier
  s_add_u32 s78, s75, 1245184
  s_add_u32 s79, s75, 1252352
  s_add_u32 s80, s73, 77824
  s_add_u32 m0, s83, 49152
  s_nop 0
  buffer_load_dwordx4 v245, s[12:15], s78 offen lds
  buffer_load_dwordx4 v245, s[12:15], s79 offen offset:1024 lds
  buffer_load_dwordx4 v244, s[8:11], s80 offen offset:2048 sc1 lds
  buffer_load_dwordx4 v244, s[8:11], s80 offen offset:3072 sc1 lds
  s_waitcnt vmcnt(24)
  s_barrier
  s_add_u32 s78, s75, 1310720
  s_add_u32 s79, s75, 1317888
  s_add_u32 s80, s73, 81920
  s_add_u32 m0, s83, 65536
  s_nop 0
  buffer_load_dwordx4 v245, s[12:15], s78 offen lds
  buffer_load_dwordx4 v245, s[12:15], s79 offen offset:1024 lds
  buffer_load_dwordx4 v244, s[8:11], s80 offen offset:2048 sc1 lds
  buffer_load_dwordx4 v244, s[8:11], s80 offen offset:3072 sc1 lds
  s_waitcnt vmcnt(24)
  s_barrier
  s_add_u32 s78, s75, 1376256
  s_add_u32 s79, s75, 1383424
  s_add_u32 s80, s73, 86016
  s_add_u32 m0, s83, 0
  s_nop 0
  buffer_load_dwordx4 v245, s[12:15], s78 offen lds
  buffer_load_dwordx4 v245, s[12:15], s79 offen offset:1024 lds
  buffer_load_dwordx4 v244, s[8:11], s80 offen offset:2048 sc1 lds
  buffer_load_dwordx4 v244, s[8:11], s80 offen offset:3072 sc1 lds
  s_waitcnt vmcnt(24)
  s_barrier
  s_add_u32 s78, s75, 1441792
  s_add_u32 s79, s75, 1448960
  s_add_u32 s80, s73, 90112
  s_add_u32 m0, s83, 81920
  s_nop 0
  buffer_load_dwordx4 v245, s[12:15], s78 offen lds
  buffer_load_dwordx4 v245, s[12:15], s79 offen offset:1024 lds
  buffer_load_dwordx4 v244, s[8:11], s80 offen offset:2048 sc1 lds
  buffer_load_dwordx4 v244, s[8:11], s80 offen offset:3072 sc1 lds
  s_waitcnt vmcnt(24)
  s_barrier
  s_add_u32 s78, s75, 1507328
  s_add_u32 s79, s75, 1514496
  s_add_u32 s80, s73, 94208
  s_add_u32 m0, s83, 16384
  s_nop 0
  buffer_load_dwordx4 v245, s[12:15], s78 offen lds
  buffer_load_dwordx4 v245, s[12:15], s79 offen offset:1024 lds
  buffer_load_dwordx4 v244, s[8:11], s80 offen offset:2048 sc1 lds
  buffer_load_dwordx4 v244, s[8:11], s80 offen offset:3072 sc1 lds
  s_waitcnt vmcnt(24)
  s_barrier
  s_add_u32 s78, s75, 1572864
  s_add_u32 s79, s75, 1580032
  s_add_u32 s80, s73, 98304
  s_add_u32 m0, s83, 32768
  s_nop 0
  buffer_load_dwordx4 v245, s[12:15], s78 offen lds
  buffer_load_dwordx4 v245, s[12:15], s79 offen offset:1024 lds
  buffer_load_dwordx4 v244, s[8:11], s80 offen offset:2048 sc1 lds
  buffer_load_dwordx4 v244, s[8:11], s80 offen offset:3072 sc1 lds
  s_waitcnt vmcnt(24)
  s_barrier
  s_add_u32 s78, s75, 1638400
  s_add_u32 s79, s75, 1645568
  s_add_u32 s80, s73, 102400
  s_add_u32 m0, s83, 98304
  s_nop 0
  buffer_load_dwordx4 v245, s[12:15], s78 offen lds
  buffer_load_dwordx4 v245, s[12:15], s79 offen offset:1024 lds
  buffer_load_dwordx4 v244, s[8:11], s80 offen offset:2048 sc1 lds
  buffer_load_dwordx4 v244, s[8:11], s80 offen offset:3072 sc1 lds
  s_waitcnt vmcnt(24)
  s_barrier
  s_add_u32 s78, s75, 1703936
  s_add_u32 s79, s75, 1711104
  s_add_u32 s80, s73, 106496
  s_add_u32 m0, s83, 131072
  s_nop 0
  buffer_load_dwordx4 v245, s[12:15], s78 offen lds
  buffer_load_dwordx4 v245, s[12:15], s79 offen offset:1024 lds
  buffer_load_dwordx4 v244, s[8:11], s80 offen offset:2048 sc1 lds
  buffer_load_dwordx4 v244, s[8:11], s80 offen offset:3072 sc1 lds
  s_waitcnt vmcnt(24)
  s_barrier
  s_add_u32 s78, s75, 1769472
  s_add_u32 s79, s75, 1776640
  s_add_u32 s80, s73, 110592
  s_add_u32 m0, s83, 114688
  s_nop 0
  buffer_load_dwordx4 v245, s[12:15], s78 offen lds
  buffer_load_dwordx4 v245, s[12:15], s79 offen offset:1024 lds
  buffer_load_dwordx4 v244, s[8:11], s80 offen offset:2048 sc1 lds
  buffer_load_dwordx4 v244, s[8:11], s80 offen offset:3072 sc1 lds
  s_waitcnt vmcnt(24)
  s_barrier
  s_add_u32 s78, s76, 640
  s_add_u32 s79, s76, 7808
  s_add_u32 s80, s74, 53248
  s_add_u32 m0, s83, 49152
  s_nop 0
  buffer_load_dwordx4 v246, s[20:23], s78 offen lds
  buffer_load_dwordx4 v247, s[20:23], s79 offen offset:1024 lds
  buffer_load_dwordx4 v244, s[8:11], s80 offen offset:2048 sc1 lds
  buffer_load_dwordx4 v244, s[8:11], s80 offen offset:3072 sc1 lds
  s_waitcnt vmcnt(24)
  s_barrier
  s_add_u32 s78, s76, 768
  s_add_u32 s79, s76, 7936
  s_add_u32 s80, s74, 24576
  s_add_u32 m0, s83, 65536
  s_nop 0
  buffer_load_dwordx4 v246, s[16:19], s78 offen lds
  buffer_load_dwordx4 v247, s[16:19], s79 offen offset:1024 lds
  buffer_load_dwordx4 v244, s[8:11], s80 offen offset:2048 sc1 lds
  buffer_load_dwordx4 v244, s[8:11], s80 offen offset:3072 sc1 lds
  s_waitcnt vmcnt(24)
  s_barrier
  s_add_u32 s78, s76, 768
  s_add_u32 s79, s76, 7936
  s_add_u32 s80, s74, 57344
  s_add_u32 m0, s83, 0
  s_nop 0
  buffer_load_dwordx4 v246, s[20:23], s78 offen lds
  buffer_load_dwordx4 v247, s[20:23], s79 offen offset:1024 lds
  buffer_load_dwordx4 v244, s[8:11], s80 offen offset:2048 sc1 lds
  buffer_load_dwordx4 v244, s[8:11], s80 offen offset:3072 sc1 lds
  s_waitcnt vmcnt(24)
  s_barrier
  s_add_u32 s78, s76, 896
  s_add_u32 s79, s76, 8064
  s_add_u32 s80, s74, 28672
  s_add_u32 m0, s83, 81920
  s_nop 0
  buffer_load_dwordx4 v246, s[16:19], s78 offen lds
  buffer_load_dwordx4 v247, s[16:19], s79 offen offset:1024 lds
  buffer_load_dwordx4 v244, s[8:11], s80 offen offset:2048 sc1 lds
  buffer_load_dwordx4 v244, s[8:11], s80 offen offset:3072 sc1 lds
  s_waitcnt vmcnt(24)
  s_barrier
  s_add_u32 s78, s76, 896
  s_add_u32 s79, s76, 8064
  s_add_u32 s80, s74, 61440
  s_add_u32 m0, s83, 16384
  s_nop 0
  buffer_load_dwordx4 v246, s[20:23], s78 offen lds
  buffer_load_dwordx4 v247, s[20:23], s79 offen offset:1024 lds
  buffer_load_dwordx4 v244, s[8:11], s80 offen offset:2048 sc1 lds
  buffer_load_dwordx4 v244, s[8:11], s80 offen offset:3072 sc1 lds
  s_waitcnt vmcnt(24)
  s_barrier
  s_waitcnt vmcnt(20)
  s_barrier
  s_waitcnt vmcnt(16)
  s_barrier
  s_waitcnt vmcnt(12)
  s_barrier
  s_waitcnt vmcnt(8)
  s_barrier
  s_waitcnt vmcnt(4)
  s_barrier
  s_waitcnt vmcnt(0)
  s_barrier
  s_waitcnt lgkmcnt(0)
L_exit:
  s_endpgm
L_asg_s:
  s_mov_b32 s86, 0
L_asg_l:
  ds_read_b32 v38, v13 offset:0
  s_waitcnt lgkmcnt(0)
  v_cmp_gt_u32 vcc, 1, v38
  s_cbranch_vccz L_asg_k
  s_add_u32 s86, s86, 1
  s_cmp_lt_u32 s86, 200000
  s_cbranch_scc1 L_asg_l
  s_branch L_asg_k
L_A_gslow:
  s_cmp_ge_u32 s86, 4000
  s_cbranch_scc1 L_A_gok
  s_sleep 16
  s_add_u32 s69, s90, 0
  buffer_load_dwordx4 v[160:163], v44, s[8:11], s69 offen sc1
  s_add_u32 s69, s90, 4096
  buffer_load_dwordx4 v[164:167], v44, s[8:11], s69 offen sc1
  s_add_u32 s69, s90, 8192
  buffer_load_dwordx4 v[168:171], v44, s[8:11], s69 offen sc1
  s_add_u32 s69, s90, 12288
  buffer_load_dwordx4 v[172:175], v44, s[8:11], s69 offen sc1
  s_add_u32 s69, s90, 16384
  buffer_load_dwordx4 v[176:179], v44, s[8:11], s69 offen sc1
  s_add_u32 s69, s90, 20480
  buffer_load_dwordx4 v[180:183], v44, s[8:11], s69 offen sc1
  s_add_u32 s69, s90, 24576
  buffer_load_dwordx4 v[184:187], v44, s[8:11], s69 offen sc1
  s_add_u32 s69, s90, 28672
  buffer_load_dwordx4 v[188:191], v44, s[8:11], s69 offen sc1
  s_waitcnt vmcnt(0)
  s_branch L_A_gchk
L_A_cslow:
  s_cmp_ge_u32 s86, 4000
  s_cbranch_scc1 L_A_cok
  s_sleep 16
  buffer_load_dwordx4 v[128:131], v43, s[28:31], 0 offen sc1
  v_subrev_u32 v209, 1024, v43
  buffer_load_dwordx4 v[132:135], v209, s[28:31], 0 offen sc1
  v_subrev_u32 v208, 2048, v43
  buffer_load_dwordx4 v[136:139], v208, s[28:31], 0 offen sc1
  v_subrev_u32 v209, 3072, v43
  buffer_load_dwordx4 v[140:143], v209, s[28:31], 0 offen sc1
  v_subrev_u32 v208, 4096, v43
  buffer_load_dwordx4 v[144:147], v208, s[28:31], 0 offen sc1
  v_subrev_u32 v209, 5120, v43
  buffer_load_dwordx4 v[148:151], v209, s[28:31], 0 offen sc1
  v_subrev_u32 v208, 6144, v43
  buffer_load_dwordx4 v[152:155], v208, s[28:31], 0 offen sc1
  v_subrev_u32 v209, 7168, v43
  buffer_load_dwordx4 v[156:159], v209, s[28:31], 0 offen sc1
  s_waitcnt vmcnt(0)
  s_branch L_A_cchk
L_f0_s:
  s_mov_b32 s86, 0
L_f0_l:
  s_sleep 8
  buffer_load_dword v251, v250, s[8:11], s77 offen sc1
  s_waitcnt vmcnt(0)
  v_cmp_ne_u32 vcc, s66, v251
  s_and_b64 vcc, vcc, s[92:93]
  s_cbranch_vccz L_f0_k
  s_add_u32 s86, s86, 1
  s_cmp_lt_u32 s86, 4000
  s_cbranch_scc1 L_f0_l
  s_branch L_f0_k
L_g0_s:
  s_mov_b32 s86, 0
L_g0_l:
  ds_read_b32 v37, v13 offset:1024
  s_waitcnt lgkmcnt(0)
  v_cmp_gt_u32 vcc, 9, v37
  s_cbranch_vccz L_g0_k
  s_add_u32 s86, s86, 1
  s_cmp_lt_u32 s86, 200000
  s_cbranch_scc1 L_g0_l
  s_branch L_g0_k
L_g1_s:
  s_mov_b32 s86, 0
L_g1_l:
  ds_read_b32 v37, v13 offset:1024
  s_waitcnt lgkmcnt(0)
  v_cmp_gt_u32 vcc, 10, v37
  s_cbranch_vccz L_g1_k
  s_add_u32 s86, s86, 1
  s_cmp_lt_u32 s86, 200000
  s_cbranch_scc1 L_g1_l
  s_branch L_g1_k
L_g2_s:
  s_mov_b32 s86, 0
L_g2_l:
  ds_read_b32 v37, v13 offset:1024
  s_waitcnt lgkmcnt(0)
  v_cmp_gt_u32 vcc, 11, v37
  s_cbranch_vccz L_g2_k
  s_add_u32 s86, s86, 1
  s_cmp_lt_u32 s86, 200000
  s_cbranch_scc1 L_g2_l
  s_branch L_g2_k
L_g3_s:
  s_mov_b32 s86, 0
L_g3_l:
  ds_read_b32 v37, v13 offset:1024
  s_waitcnt lgkmcnt(0)
  v_cmp_gt_u32 vcc, 12, v37
  s_cbranch_vccz L_g3_k
  s_add_u32 s86, s86, 1
  s_cmp_lt_u32 s86, 200000
  s_cbranch_scc1 L_g3_l
  s_branch L_g3_k
L_g4_s:
  s_mov_b32 s86, 0
L_g4_l:
  ds_read_b32 v37, v13 offset:1024
  s_waitcnt lgkmcnt(0)
  v_cmp_gt_u32 vcc, 13, v37
  s_cbranch_vccz L_g4_k
  s_add_u32 s86, s86, 1
  s_cmp_lt_u32 s86, 200000
  s_cbranch_scc1 L_g4_l
  s_branch L_g4_k
L_g5_s:
  s_mov_b32 s86, 0
L_g5_l:
  ds_read_b32 v37, v13 offset:1024
  s_waitcnt lgkmcnt(0)
  v_cmp_gt_u32 vcc, 14, v37
  s_cbranch_vccz L_g5_k
  s_add_u32 s86, s86, 1
  s_cmp_lt_u32 s86, 200000
  s_cbranch_scc1 L_g5_l
  s_branch L_g5_k
L_g6_s:
  s_mov_b32 s86, 0
L_g6_l:
  ds_read_b32 v37, v13 offset:1024
  s_waitcnt lgkmcnt(0)
  v_cmp_gt_u32 vcc, 15, v37
  s_cbranch_vccz L_g6_k
  s_add_u32 s86, s86, 1
  s_cmp_lt_u32 s86, 200000
  s_cbranch_scc1 L_g6_l
  s_branch L_g6_k
L_g7_s:
  s_mov_b32 s86, 0
L_g7_l:
  ds_read_b32 v37, v13 offset:1024
  s_waitcnt lgkmcnt(0)
  v_cmp_gt_u32 vcc, 16, v37
  s_cbranch_vccz L_g7_k
  s_add_u32 s86, s86, 1
  s_cmp_lt_u32 s86, 200000
  s_cbranch_scc1 L_g7_l
  s_branch L_g7_k
L_g8_s:
  s_mov_b32 s86, 0
L_g8_l:
  ds_read_b32 v37, v13 offset:1024
  s_waitcnt lgkmcnt(0)
  v_cmp_gt_u32 vcc, 17, v37
  s_cbranch_vccz L_g8_k
  s_add_u32 s86, s86, 1
  s_cmp_lt_u32 s86, 200000
  s_cbranch_scc1 L_g8_l
  s_branch L_g8_k
L_end:
.section .rodata,"a"
.p2align 6
.amdhsa_kernel recurrent_scan__ssm_conv_s5__glu_gated_swiglu__prompt_kernel
  .amdhsa_next_free_vgpr 256
  .amdhsa_next_free_sgpr 102
  .amdhsa_accum_offset 256
  .amdhsa_group_segment_fixed_size 0
  .amdhsa_kernarg_size 128
  .amdhsa_user_sgpr_count 2
  .amdhsa_user_sgpr_kernarg_segment_ptr 1
  .amdhsa_system_sgpr_workgroup_id_x 1
.end_amdhsa_kernel
```
